```python
import torch

def _softmax(x, axis=-1):
    return torch.softmax(x, dim=axis)
def _gelu(x):
    return torch.nn.functional.gelu(x, approximate="tanh")
def _silu(x):
    return torch.nn.functional.silu(x)
def _sigmoid(x):
    return torch.sigmoid(x)
def _layernorm(x, axis=-1, eps=1e-5):
    m = x.mean(dim=axis, keepdim=True)
    v = x.var(dim=axis, keepdim=True, unbiased=False)
    return (x - m) / torch.sqrt(v + eps)
def _scatter_add(tgt, idx, src, axis=0):
    return tgt.clone().index_add_(axis, idx, src)
def _segment_sum(src, seg, n):
    out = torch.zeros((n,) + src.shape[1:], dtype=src.dtype)
    return out.index_add_(0, seg, src)
def _pad(x, pw):
    flat = tuple(v for pair in reversed(pw) for v in pair)
    return torch.nn.functional.pad(x, flat)

kernel_name = 'gated_mix__ssm_conv_h3__dense_activation_relu__prompt'

def setup_inputs():

    _w = (lambda a: (lambda t: t.to(torch.bfloat16) if t.is_floating_point() else t)(torch.as_tensor(a)))
    def _A_setup():
        B, S, D = 1, 2048, 512
        ks = 4
        return {
            "q": _w((lambda *s: torch.randn(*s, dtype=torch.bfloat16) * 0.05)(B, S, D)),
            "k": _w((lambda *s: torch.randn(*s, dtype=torch.bfloat16) * 0.8)(B, S, D)),
            "v": _w((lambda *s: torch.randn(*s, dtype=torch.bfloat16) * 0.8)(B, S, D)),
            "shift_k": _w((lambda *s: torch.randn(*s, dtype=torch.bfloat16) * 0.8)(D, ks) * 0.5),
            "ssm_k": _w((lambda *s: torch.randn(*s, dtype=torch.bfloat16) * 0.8)(D, S) * (1.0 / S ** 0.5)),
            "ssm_D": _w((lambda *s: torch.randn(*s, dtype=torch.bfloat16) * 0.8)(D)),
        }
    _A_in = _A_setup()

    def _B_setup():
        B, S, D, Dff = 1, 2048, 512, 1792
        return {
            "x": _w((lambda *s: torch.randn(*s, dtype=torch.bfloat16) * 0.05)(B, S, D)),
            "w1": _w((lambda *s: torch.randn(*s, dtype=torch.bfloat16) * 0.05)(D, Dff)),
            "w2": _w((lambda *s: torch.randn(*s, dtype=torch.bfloat16) * 0.05)(Dff, D)),
        }
    _B_in = _B_setup()

    return {
        "A_q": _A_in["q"],
        "A_k": _A_in["k"],
        "A_v": _A_in["v"],
        "A_shift_k": _A_in["shift_k"],
        "A_ssm_k": _A_in["ssm_k"],
        "A_ssm_D": _A_in["ssm_D"],
        "B_x": _B_in["x"],
        "B_w1": _B_in["w1"],
        "B_w2": _B_in["w2"],
        "gate_w": _w((lambda *s: torch.randn(*s, dtype=torch.bfloat16) * 0.05)(512) * 16.0),
    }

def reference(A_q, A_k, A_v, A_shift_k, A_ssm_k, A_ssm_D, B_x, B_w1, B_w2, gate_w):
    def _A_ref(q, k, v, shift_k, ssm_k, ssm_D):
        B, S, D = q.shape
        ks = shift_k.shape[-1]
        k_pad = _pad(k, ((0, 0), (ks - 1, 0), (0, 0)))
        k_shift = torch.zeros_like(k)
        for t in range(ks):
            k_shift = k_shift + k_pad[:, t:t + S, :] * shift_k[:, ks - 1 - t][None, None, :]
        kv = k_shift * v
        L = 2 * S
        kv_pad = _pad(kv, ((0, 0), (0, S), (0, 0)))
        kf_pad = _pad(ssm_k, ((0, 0), (0, S)))
        kv_f = (lambda x, axes=(-2,-1): torch.fft.rfft2(x.float(), dim=axes))(kv_pad[:, None, :, :], axes=(1, 2))
        kf_f = (lambda x, axes=(-2,-1): torch.fft.rfft2(x.float(), dim=axes))(kf_pad[:, None, :], axes=(1, 2))
        kf_f = (lambda x, *d: x.permute(*d))(kf_f, 1, 2, 0)
        y_f = kv_f * kf_f[None, :, :, :]
        y = (lambda x, s, axes=(-2,-1): torch.fft.irfft2(x, s=s, dim=axes).to(torch.bfloat16))(y_f, (1, L), axes=(1, 2))[:, 0, :S, :]
        y = y + kv * ssm_D[None, None, :]
        return q * y

    def _B_ref(x, w1, w2):
        h = torch.einsum("bsd,df->bsf", x, w1)
        zero = torch.zeros_like(h)
        h = torch.maximum(h, zero)
        return torch.einsum("bsf,fd->bsd", h, w2)

    x = A_q
    g = _sigmoid((x * gate_w).sum(-1, keepdims=True))
    a = _A_ref(x, A_k, A_v, A_shift_k, A_ssm_k, A_ssm_D)
    b = _B_ref(x, B_w1, B_w2)
    return g * a + (1 - g) * b
```

```asm
; @launch kernel=p_kernel grid=(256,1,1) block=(256,1,1) lds=163840
.amdgcn_target "amdgcn-amd-amdhsa--gfx950"
.text
.globl p_kernel
.p2align 8
.type p_kernel,@function
p_kernel:
    s_cmp_ge_u32 s2, 256
    s_cbranch_scc1 P_END
    s_load_dwordx16 s[64:79], s[0:1], 0
    s_load_dwordx8 s[80:87], s[0:1], 64
    s_load_dwordx2 s[88:89], s[0:1], 96
    v_lshrrev_b32 v1, 6, v0
    s_nop 0
    v_readfirstlane_b32 s3, v1
    v_and_b32 v1, 63, v0
    s_and_b32 s58, s2, 7
    s_lshr_b32 s59, s2, 3
    v_mov_b32 v244, 0
    v_mov_b32 v246, 0
    v_mov_b32 v248, 0
    s_mov_b32 s77, 0
    s_mov_b32 s45, 0
    s_mov_b32 s46, 0
    s_waitcnt lgkmcnt(0)
    s_mov_b32 s4, s64
    s_and_b32 s5, s65, 0xffff
    s_mov_b32 s6, 2097152
    s_mov_b32 s7, 0x00020000
    s_mov_b32 s8, s66
    s_and_b32 s9, s67, 0xffff
    s_mov_b32 s10, 2097152
    s_mov_b32 s11, 0x00020000
    s_mov_b32 s12, s68
    s_and_b32 s13, s69, 0xffff
    s_mov_b32 s14, 2097152
    s_mov_b32 s15, 0x00020000
    s_mov_b32 s16, s70
    s_and_b32 s17, s71, 0xffff
    s_mov_b32 s18, 4096
    s_mov_b32 s19, 0x00020000
    s_mov_b32 s24, s78
    s_and_b32 s25, s79, 0xffff
    s_mov_b32 s26, 1835008
    s_mov_b32 s27, 0x00020000
    s_mov_b32 s28, s82
    s_and_b32 s29, s83, 0xffff
    s_mov_b32 s30, 1024
    s_mov_b32 s31, 0x00020000
    s_mov_b32 s32, s88
    s_and_b32 s33, s89, 0xffff
    s_mov_b32 s34, 16777216
    s_mov_b32 s35, 0x00020000
    s_mov_b32 s20, s86
    s_and_b32 s21, s87, 0xffff
    s_mov_b32 s22, 256
    s_mov_b32 s23, 0x00020000
    s_cmp_ge_u32 s59, 28
    s_cbranch_scc1 P_NOG1
    v_lshrrev_b32 v2, 5, v1
    v_and_b32 v6, 31, v1
    s_lshl_b32 s36, s59, 6
    s_lshl_b32 s38, s3, 4
    s_add_u32 s36, s36, s38
    v_lshlrev_b32 v2, 3, v2
    v_add_u32 v3, s36, v2
    s_lshl_b32 s37, s58, 6
    v_lshlrev_b32 v6, 1, v6
    v_add_u32 v6, s37, v6
    v_lshlrev_b32 v4, 10, v3
    v_lshl_add_u32 v4, v6, 1, v4
    v_subrev_u32 v5, 3072, v4
    v_cmp_eq_u32 vcc, 0, v3
    v_mov_b32 v7, 0x80000000
    s_nop 1
    v_cndmask_b32 v5, v5, v7, vcc
    s_movk_i32 s39, 0x1000
    buffer_load_dword v16, v5, s[8:11], 0 offen
    buffer_load_dword v17, v5, s[8:11], 0 offen offset:1024
    buffer_load_dword v18, v5, s[8:11], 0 offen offset:2048

    buffer_load_dword v19, v4, s[8:11], 0 offen offset:0
    buffer_load_dword v20, v4, s[8:11], 0 offen offset:1024
    buffer_load_dword v21, v4, s[8:11], 0 offen offset:2048
    buffer_load_dword v22, v4, s[8:11], 0 offen offset:3072
    buffer_load_dword v23, v4, s[8:11], s39 offen offset:0
    buffer_load_dword v24, v4, s[8:11], s39 offen offset:1024
    buffer_load_dword v25, v4, s[8:11], s39 offen offset:2048
    buffer_load_dword v26, v4, s[8:11], s39 offen offset:3072
    buffer_load_dword v27, v4, s[12:15], 0 offen offset:0
    buffer_load_dword v28, v4, s[12:15], 0 offen offset:1024
    buffer_load_dword v29, v4, s[12:15], 0 offen offset:2048
    buffer_load_dword v30, v4, s[12:15], 0 offen offset:3072
    buffer_load_dword v31, v4, s[12:15], s39 offen offset:0
    buffer_load_dword v32, v4, s[12:15], s39 offen offset:1024
    buffer_load_dword v33, v4, s[12:15], s39 offen offset:2048
    buffer_load_dword v34, v4, s[12:15], s39 offen offset:3072
    v_lshlrev_b32 v8, 3, v6
    buffer_load_dwordx4 v[36:39], v8, s[16:19], 0 offen
    v_mov_b32 v124, v3
    v_mov_b32 v125, v6

    s_cmp_ge_u32 s59, 14
    s_cselect_b32 s60, 1, 0
    s_cselect_b32 s61, 14, 0
    s_sub_u32 s61, s59, s61
    s_lshl_b32 s62, s58, 1
    s_add_u32 s60, s60, s62

    s_lshl_b32 s55, s60, 7
    s_lshl_b32 s56, s61, 8
    s_lshl_b32 s48, s55, 10
    s_mul_i32 s49, s3, 14336
    s_add_u32 s49, s49, s56
    s_lshl_b32 s50, s3, 10
    s_lshr_b32 s51, s3, 1
    s_and_b32 s52, s3, 1
    s_and_b32 s41, s61, 7
    s_lshl_b32 s41, s41, 4
    s_add_u32 s41, s41, s55
    s_lshl_b32 s42, s3, 2
    s_add_u32 s41, s41, s42
    s_lshl_b32 s76, s60, 9
    s_lshl_b32 s42, s61, 2
    s_add_u32 s76, s76, s42
    s_add_u32 s76, s76, 13639680

    s_lshl_b32 s42, s41, 10
    v_lshlrev_b32 v9, 4, v1
    buffer_load_dwordx4 v[40:43], v9, s[4:7], s42 offen
    buffer_load_dwordx4 v[44:47], v9, s[4:7], s42 offen offset:1024
    buffer_load_dwordx4 v[248:251], v9, s[4:7], s42 offen offset:2048
    buffer_load_dwordx4 v[252:255], v9, s[4:7], s42 offen offset:3072
    buffer_load_dwordx4 v[48:51], v9, s[28:31], 0 offen

    v_lshrrev_b32 v2, 3, v1
    s_lshl_b32 s53, s3, 3
    v_add_u32 v2, s53, v2
    v_lshlrev_b32 v2, 10, v2
    v_lshrrev_b32 v3, 4, v1
    s_and_b32 s53, s3, 1
    s_lshl_b32 s53, s53, 2
    v_add_u32 v4, s53, v3
    v_and_b32 v5, 7, v1
    v_xor_b32 v5, v5, v4
    v_lshl_add_u32 v242, v5, 4, v2
    v_mul_u32_u24 v2, 3584, v3
    v_and_b32 v5, 15, v1
    v_lshlrev_b32 v4, 2, v3
    v_xor_b32 v5, v5, v4
    v_lshl_add_u32 v243, v5, 4, v2
    v_and_b32 v2, 31, v1
    v_lshlrev_b32 v2, 7, v2
    s_lshl_b32 s53, s51, 13
    v_add_u32 v2, s53, v2
    v_lshrrev_b32 v3, 5, v1
    v_bfe_u32 v4, v1, 1, 3
    v_xor_b32 v4, v3, v4
    v_lshl_add_u32 v2, v4, 4, v2

    v_xor_b32 v224, 0, v2
    v_add_u32 v225, 0x10000, v224
    v_add_u32 v226, 0x20000, v224
    v_xor_b32 v227, 32, v2
    v_add_u32 v228, 0x10000, v227
    v_add_u32 v229, 0x20000, v227
    v_xor_b32 v230, 64, v2
    v_add_u32 v231, 0x10000, v230
    v_add_u32 v232, 0x20000, v230
    v_xor_b32 v233, 96, v2
    v_add_u32 v234, 0x10000, v233
    v_add_u32 v235, 0x20000, v233
    v_bfe_u32 v4, v1, 2, 2
    v_and_b32 v5, 3, v1
    v_bfe_u32 v6, v1, 4, 1
    v_lshl_add_u32 v7, v3, 3, v4
    v_lshlrev_b32 v7, 8, v7
    v_add_u32 v7, 16384, v7
    v_and_b32 v8, 1, v5
    v_lshl_add_u32 v7, v8, 3, v7
    v_lshrrev_b32 v8, 1, v5
    v_lshl_add_u32 v8, v6, 1, v8
    s_lshl_b32 s53, s52, 3
    v_add_u32 v8, s53, v8
    v_lshlrev_b32 v9, 2, v4
    v_xor_b32 v10, v8, v9
    v_lshl_add_u32 v236, v10, 4, v7
    v_add_u32 v8, 4, v8
    v_xor_b32 v10, v8, v9
    v_lshl_add_u32 v239, v10, 4, v7
    v_add_u32 v237, 0x10000, v236
    v_add_u32 v240, 0x10000, v239
    v_add_u32 v238, 0x20000, v236
    v_add_u32 v241, 0x20000, v239

    s_add_u32 m0, s50, 0
    s_add_u32 s54, s48, 0
    buffer_load_dwordx4 v242, s[4:7], s54 offen lds
    s_add_u32 m0, s50, 4096
    s_add_u32 s54, s48, 32768
    buffer_load_dwordx4 v242, s[4:7], s54 offen lds
    s_add_u32 m0, s50, 8192
    s_add_u32 s54, s48, 65536
    buffer_load_dwordx4 v242, s[4:7], s54 offen lds
    s_add_u32 m0, s50, 12288
    s_add_u32 s54, s48, 98304
    buffer_load_dwordx4 v242, s[4:7], s54 offen lds
    s_add_u32 m0, s50, 16384
    s_add_u32 s54, s49, 0
    buffer_load_dwordx4 v243, s[24:27], s54 offen lds
    s_add_u32 m0, s50, 20480
    s_add_u32 s54, s49, 57344
    buffer_load_dwordx4 v243, s[24:27], s54 offen lds
    s_add_u32 m0, s50, 24576
    s_add_u32 s54, s49, 114688
    buffer_load_dwordx4 v243, s[24:27], s54 offen lds
    s_add_u32 m0, s50, 28672
    s_add_u32 s54, s49, 172032
    buffer_load_dwordx4 v243, s[24:27], s54 offen lds
    s_add_u32 m0, s50, 32768
    s_add_u32 s54, s48, 128
    buffer_load_dwordx4 v242, s[4:7], s54 offen lds
    s_add_u32 m0, s50, 36864
    s_add_u32 s54, s48, 32896
    buffer_load_dwordx4 v242, s[4:7], s54 offen lds
    s_add_u32 m0, s50, 40960
    s_add_u32 s54, s48, 65664
    buffer_load_dwordx4 v242, s[4:7], s54 offen lds
    s_add_u32 m0, s50, 45056
    s_add_u32 s54, s48, 98432
    buffer_load_dwordx4 v242, s[4:7], s54 offen lds
    s_add_u32 m0, s50, 49152
    s_add_u32 s54, s49, 229376
    buffer_load_dwordx4 v243, s[24:27], s54 offen lds
    s_add_u32 m0, s50, 53248
    s_add_u32 s54, s49, 286720
    buffer_load_dwordx4 v243, s[24:27], s54 offen lds
    s_add_u32 m0, s50, 57344
    s_add_u32 s54, s49, 344064
    buffer_load_dwordx4 v243, s[24:27], s54 offen lds
    s_add_u32 m0, s50, 61440
    s_add_u32 s54, s49, 401408
    buffer_load_dwordx4 v243, s[24:27], s54 offen lds
    s_add_u32 m0, s50, 65536
    s_add_u32 s54, s48, 256
    buffer_load_dwordx4 v242, s[4:7], s54 offen lds
    s_add_u32 m0, s50, 69632
    s_add_u32 s54, s48, 33024
    buffer_load_dwordx4 v242, s[4:7], s54 offen lds
    s_add_u32 m0, s50, 73728
    s_add_u32 s54, s48, 65792
    buffer_load_dwordx4 v242, s[4:7], s54 offen lds
    s_add_u32 m0, s50, 77824
    s_add_u32 s54, s48, 98560
    buffer_load_dwordx4 v242, s[4:7], s54 offen lds
    s_add_u32 m0, s50, 81920
    s_add_u32 s54, s49, 458752
    buffer_load_dwordx4 v243, s[24:27], s54 offen lds
    s_add_u32 m0, s50, 86016
    s_add_u32 s54, s49, 516096
    buffer_load_dwordx4 v243, s[24:27], s54 offen lds
    s_add_u32 m0, s50, 90112
    s_add_u32 s54, s49, 573440
    buffer_load_dwordx4 v243, s[24:27], s54 offen lds
    s_add_u32 m0, s50, 94208
    s_add_u32 s54, s49, 630784
    buffer_load_dwordx4 v243, s[24:27], s54 offen lds
    s_waitcnt vmcnt(24)
    v_mov_b32 v3, v124
    v_mov_b32 v6, v125
    v_lshlrev_b32 v52, 16, v16
    v_and_b32 v53, 0xffff0000, v16
    v_lshlrev_b32 v54, 16, v17
    v_and_b32 v55, 0xffff0000, v17
    v_lshlrev_b32 v56, 16, v18
    v_and_b32 v57, 0xffff0000, v18
    v_lshlrev_b32 v58, 16, v19
    v_and_b32 v59, 0xffff0000, v19
    v_lshlrev_b32 v60, 16, v20
    v_and_b32 v61, 0xffff0000, v20
    v_lshlrev_b32 v62, 16, v21
    v_and_b32 v63, 0xffff0000, v21
    v_lshlrev_b32 v64, 16, v22
    v_and_b32 v65, 0xffff0000, v22
    v_lshlrev_b32 v66, 16, v23
    v_and_b32 v67, 0xffff0000, v23
    v_lshlrev_b32 v68, 16, v24
    v_and_b32 v69, 0xffff0000, v24
    v_lshlrev_b32 v70, 16, v25
    v_and_b32 v71, 0xffff0000, v25
    v_lshlrev_b32 v72, 16, v26
    v_and_b32 v73, 0xffff0000, v26
    v_lshlrev_b32 v74, 16, v27
    v_and_b32 v75, 0xffff0000, v27
    v_lshlrev_b32 v76, 16, v28
    v_and_b32 v77, 0xffff0000, v28
    v_lshlrev_b32 v78, 16, v29
    v_and_b32 v79, 0xffff0000, v29
    v_lshlrev_b32 v80, 16, v30
    v_and_b32 v81, 0xffff0000, v30
    v_lshlrev_b32 v82, 16, v31
    v_and_b32 v83, 0xffff0000, v31
    v_lshlrev_b32 v84, 16, v32
    v_and_b32 v85, 0xffff0000, v32
    v_lshlrev_b32 v86, 16, v33
    v_and_b32 v87, 0xffff0000, v33
    v_lshlrev_b32 v88, 16, v34
    v_and_b32 v89, 0xffff0000, v34
    v_lshlrev_b32 v90, 16, v36
    v_lshlrev_b32 v91, 16, v38
    v_and_b32 v92, 0xffff0000, v36
    v_and_b32 v93, 0xffff0000, v38
    v_lshlrev_b32 v94, 16, v37
    v_lshlrev_b32 v95, 16, v39
    v_and_b32 v96, 0xffff0000, v37
    v_and_b32 v97, 0xffff0000, v39
    v_pk_mul_f32 v[98:99], v[52:53], v[96:97]
    v_pk_fma_f32 v[98:99], v[54:55], v[94:95], v[98:99]
    v_pk_fma_f32 v[98:99], v[56:57], v[92:93], v[98:99]
    v_pk_fma_f32 v[98:99], v[58:59], v[90:91], v[98:99]
    v_pk_mul_f32 v[100:101], v[54:55], v[96:97]
    v_pk_fma_f32 v[100:101], v[56:57], v[94:95], v[100:101]
    v_pk_fma_f32 v[100:101], v[58:59], v[92:93], v[100:101]
    v_pk_fma_f32 v[100:101], v[60:61], v[90:91], v[100:101]
    v_pk_mul_f32 v[102:103], v[56:57], v[96:97]
    v_pk_fma_f32 v[102:103], v[58:59], v[94:95], v[102:103]
    v_pk_fma_f32 v[102:103], v[60:61], v[92:93], v[102:103]
    v_pk_fma_f32 v[102:103], v[62:63], v[90:91], v[102:103]
    v_pk_mul_f32 v[104:105], v[58:59], v[96:97]
    v_pk_fma_f32 v[104:105], v[60:61], v[94:95], v[104:105]
    v_pk_fma_f32 v[104:105], v[62:63], v[92:93], v[104:105]
    v_pk_fma_f32 v[104:105], v[64:65], v[90:91], v[104:105]
    v_pk_mul_f32 v[106:107], v[60:61], v[96:97]
    v_pk_fma_f32 v[106:107], v[62:63], v[94:95], v[106:107]
    v_pk_fma_f32 v[106:107], v[64:65], v[92:93], v[106:107]
    v_pk_fma_f32 v[106:107], v[66:67], v[90:91], v[106:107]
    v_pk_mul_f32 v[108:109], v[62:63], v[96:97]
    v_pk_fma_f32 v[108:109], v[64:65], v[94:95], v[108:109]
    v_pk_fma_f32 v[108:109], v[66:67], v[92:93], v[108:109]
    v_pk_fma_f32 v[108:109], v[68:69], v[90:91], v[108:109]
    v_pk_mul_f32 v[110:111], v[64:65], v[96:97]
    v_pk_fma_f32 v[110:111], v[66:67], v[94:95], v[110:111]
    v_pk_fma_f32 v[110:111], v[68:69], v[92:93], v[110:111]
    v_pk_fma_f32 v[110:111], v[70:71], v[90:91], v[110:111]
    v_pk_mul_f32 v[112:113], v[66:67], v[96:97]
    v_pk_fma_f32 v[112:113], v[68:69], v[94:95], v[112:113]
    v_pk_fma_f32 v[112:113], v[70:71], v[92:93], v[112:113]
    v_pk_fma_f32 v[112:113], v[72:73], v[90:91], v[112:113]
    v_cvt_pk_bf16_f32 v2, v98, v99
    v_lshlrev_b32 v98, 16, v2
    v_and_b32 v99, 0xffff0000, v2
    v_pk_mul_f32 v[98:99], v[98:99], v[74:75]
    v_cvt_pk_bf16_f32 v2, v100, v101
    v_lshlrev_b32 v100, 16, v2
    v_and_b32 v101, 0xffff0000, v2
    v_pk_mul_f32 v[100:101], v[100:101], v[76:77]
    v_cvt_pk_bf16_f32 v2, v102, v103
    v_lshlrev_b32 v102, 16, v2
    v_and_b32 v103, 0xffff0000, v2
    v_pk_mul_f32 v[102:103], v[102:103], v[78:79]
    v_cvt_pk_bf16_f32 v2, v104, v105
    v_lshlrev_b32 v104, 16, v2
    v_and_b32 v105, 0xffff0000, v2
    v_pk_mul_f32 v[104:105], v[104:105], v[80:81]
    v_cvt_pk_bf16_f32 v2, v106, v107
    v_lshlrev_b32 v106, 16, v2
    v_and_b32 v107, 0xffff0000, v2
    v_pk_mul_f32 v[106:107], v[106:107], v[82:83]
    v_cvt_pk_bf16_f32 v2, v108, v109
    v_lshlrev_b32 v108, 16, v2
    v_and_b32 v109, 0xffff0000, v2
    v_pk_mul_f32 v[108:109], v[108:109], v[84:85]
    v_cvt_pk_bf16_f32 v2, v110, v111
    v_lshlrev_b32 v110, 16, v2
    v_and_b32 v111, 0xffff0000, v2
    v_pk_mul_f32 v[110:111], v[110:111], v[86:87]
    v_cvt_pk_bf16_f32 v2, v112, v113
    v_lshlrev_b32 v112, 16, v2
    v_and_b32 v113, 0xffff0000, v2
    v_pk_mul_f32 v[112:113], v[112:113], v[88:89]
    v_cvt_pk_bf16_f32 v116, v98, v100
    v_cvt_pk_bf16_f32 v120, v99, v101
    v_cvt_pk_bf16_f32 v117, v102, v104
    v_cvt_pk_bf16_f32 v121, v103, v105
    v_cvt_pk_bf16_f32 v118, v106, v108
    v_cvt_pk_bf16_f32 v122, v107, v109
    v_cvt_pk_bf16_f32 v119, v110, v112
    v_cvt_pk_bf16_f32 v123, v111, v113
    v_lshlrev_b32 v2, 12, v6
    v_lshl_add_u32 v2, v3, 1, v2
    s_mov_b32 s43, 8388608
    s_mov_b32 s44, 8392704
    buffer_store_dwordx4 v[116:119], v2, s[32:35], s43 offen sc1
    buffer_store_dwordx4 v[120:123], v2, s[32:35], s44 offen sc1

    v_mov_b32 v10, 0
    v_mov_b32 v11, 0
    v_mov_b32 v12, 0
    v_mov_b32 v13, 0
    v_dot2_f32_bf16 v10, v40, v48, v10
    v_dot2_f32_bf16 v11, v44, v48, v11
    v_dot2_f32_bf16 v12, v248, v48, v12
    v_dot2_f32_bf16 v13, v252, v48, v13
    v_dot2_f32_bf16 v10, v41, v49, v10
    v_dot2_f32_bf16 v11, v45, v49, v11
    v_dot2_f32_bf16 v12, v249, v49, v12
    v_dot2_f32_bf16 v13, v253, v49, v13
    v_dot2_f32_bf16 v10, v42, v50, v10
    v_dot2_f32_bf16 v11, v46, v50, v11
    v_dot2_f32_bf16 v12, v250, v50, v12
    v_dot2_f32_bf16 v13, v254, v50, v13
    v_dot2_f32_bf16 v10, v43, v51, v10
    v_dot2_f32_bf16 v11, v47, v51, v11
    v_dot2_f32_bf16 v12, v251, v51, v12
    v_dot2_f32_bf16 v13, v255, v51, v13
    s_nop 4
    v_add_f32_dpp v10, v10, v10 row_shr:1 row_mask:0xf bank_mask:0xf bound_ctrl:0
    v_add_f32_dpp v11, v11, v11 row_shr:1 row_mask:0xf bank_mask:0xf bound_ctrl:0
    v_add_f32_dpp v12, v12, v12 row_shr:1 row_mask:0xf bank_mask:0xf bound_ctrl:0
    v_add_f32_dpp v13, v13, v13 row_shr:1 row_mask:0xf bank_mask:0xf bound_ctrl:0
    s_nop 1
    v_add_f32_dpp v10, v10, v10 row_shr:2 row_mask:0xf bank_mask:0xf bound_ctrl:0
    v_add_f32_dpp v11, v11, v11 row_shr:2 row_mask:0xf bank_mask:0xf bound_ctrl:0
    v_add_f32_dpp v12, v12, v12 row_shr:2 row_mask:0xf bank_mask:0xf bound_ctrl:0
    v_add_f32_dpp v13, v13, v13 row_shr:2 row_mask:0xf bank_mask:0xf bound_ctrl:0
    s_nop 1
    v_add_f32_dpp v10, v10, v10 row_shr:4 row_mask:0xf bank_mask:0xf bound_ctrl:0
    v_add_f32_dpp v11, v11, v11 row_shr:4 row_mask:0xf bank_mask:0xf bound_ctrl:0
    v_add_f32_dpp v12, v12, v12 row_shr:4 row_mask:0xf bank_mask:0xf bound_ctrl:0
    v_add_f32_dpp v13, v13, v13 row_shr:4 row_mask:0xf bank_mask:0xf bound_ctrl:0
    s_nop 1
    v_add_f32_dpp v10, v10, v10 row_shr:8 row_mask:0xf bank_mask:0xf bound_ctrl:0
    v_add_f32_dpp v11, v11, v11 row_shr:8 row_mask:0xf bank_mask:0xf bound_ctrl:0
    v_add_f32_dpp v12, v12, v12 row_shr:8 row_mask:0xf bank_mask:0xf bound_ctrl:0
    v_add_f32_dpp v13, v13, v13 row_shr:8 row_mask:0xf bank_mask:0xf bound_ctrl:0
    s_nop 1
    v_add_f32_dpp v10, v10, v10 row_bcast:15 row_mask:0xa bank_mask:0xf
    v_add_f32_dpp v11, v11, v11 row_bcast:15 row_mask:0xa bank_mask:0xf
    v_add_f32_dpp v12, v12, v12 row_bcast:15 row_mask:0xa bank_mask:0xf
    v_add_f32_dpp v13, v13, v13 row_bcast:15 row_mask:0xa bank_mask:0xf
    s_nop 1
    v_add_f32_dpp v10, v10, v10 row_bcast:31 row_mask:0xc bank_mask:0xf
    v_add_f32_dpp v11, v11, v11 row_bcast:31 row_mask:0xc bank_mask:0xf
    v_add_f32_dpp v12, v12, v12 row_bcast:31 row_mask:0xc bank_mask:0xf
    v_add_f32_dpp v13, v13, v13 row_bcast:31 row_mask:0xc bank_mask:0xf
    s_nop 1
    v_readlane_b32 s44, v10, 63
    v_readlane_b32 s45, v11, 63
    v_readlane_b32 s46, v12, 63
    v_readlane_b32 s47, v13, 63
    s_nop 3
    v_mov_b32 v10, s44
    v_mov_b32 v11, s45
    v_mov_b32 v12, s46
    v_mov_b32 v13, s47
    v_cvt_pk_bf16_f32 v10, v10, v11
    v_cvt_pk_bf16_f32 v12, v12, v13
    v_and_b32 v11, 0xffff0000, v10
    v_lshlrev_b32 v10, 16, v10
    v_and_b32 v13, 0xffff0000, v12
    v_lshlrev_b32 v12, 16, v12

    v_mul_f32 v10, 0xbfb8aa3b, v10
    v_mul_f32 v11, 0xbfb8aa3b, v11
    v_mul_f32 v12, 0xbfb8aa3b, v12
    v_mul_f32 v13, 0xbfb8aa3b, v13
    v_exp_f32 v10, v10
    v_exp_f32 v11, v11
    v_exp_f32 v12, v12
    v_exp_f32 v13, v13
    s_nop 0
    v_add_f32 v10, 1.0, v10
    v_add_f32 v11, 1.0, v11
    v_add_f32 v12, 1.0, v12
    v_add_f32 v13, 1.0, v13
    v_rcp_f32 v10, v10
    v_rcp_f32 v11, v11
    v_rcp_f32 v12, v12
    v_rcp_f32 v13, v13
    s_nop 0
    v_cvt_pk_bf16_f32 v10, v10, v11
    v_cvt_pk_bf16_f32 v12, v12, v13
    v_and_b32 v11, 0xffff0000, v10
    v_lshlrev_b32 v10, 16, v10
    v_and_b32 v13, 0xffff0000, v12
    v_lshlrev_b32 v12, 16, v12
    s_lshl_b32 s42, s41, 2
    s_add_u32 s42, s42, 12582912
    v_mov_b32 v14, 0
    v_cmp_eq_u32 vcc, 0, v1
    s_and_saveexec_b64 s[46:47], vcc
    buffer_store_dwordx4 v[10:13], v14, s[32:35], s42 offen sc1
    s_mov_b64 exec, s[46:47]

    s_mov_b32 s8, s80
    s_and_b32 s9, s81, 0xffff
    s_mov_b32 s10, 1835008
    s_mov_b32 s11, 0x00020000
    s_mov_b32 s12, s84
    s_and_b32 s13, s85, 0xffff
    s_mov_b32 s14, 2097152
    s_mov_b32 s15, 0x00020000
    s_mov_b32 s16, s72
    s_and_b32 s17, s73, 0xffff
    s_mov_b32 s18, 2097152
    s_mov_b32 s19, 0x00020000
    s_mov_b32 s28, s74
    s_and_b32 s29, s75, 0xffff
    s_mov_b32 s30, 1024
    s_mov_b32 s31, 0x00020000
    s_lshr_b32 s36, s3, 1
    s_and_b32 s37, s3, 1
    s_lshl_b32 s42, s2, 1
    s_add_u32 s42, s42, s36
    s_lshl_b32 s38, s42, 12
    s_mul_i32 s39, s36, 16640
    s_add_u32 s39, s39, 32768
    s_mul_i32 s40, s36, 4608
    s_add_u32 s40, s40, 131072
    s_lshl_b32 s41, s37, 11

    s_and_b32 s47, s59, 7
    s_mul_i32 s47, s47, 229376
    s_lshl_b32 s53, s3, 13
    s_add_u32 s47, s47, s53
    s_add_u32 s47, s47, 14745600
    v_lshlrev_b32 v252, 4, v1

    v_lshlrev_b32 v126, 4, v1
    v_add_u32 v126, s50, v126
    v_add_u32 v127, 0x10000, v126
    s_waitcnt vmcnt(19)
    s_barrier
    ds_read_b128 v[192:195], v224 offset:0
    ds_read_b128 v[196:199], v224 offset:4096
    ds_read_b64_tr_b16 v[200:201], v236 offset:0
    ds_read_b64_tr_b16 v[202:203], v236 offset:1024
    ds_read_b64_tr_b16 v[204:205], v239 offset:0
    ds_read_b64_tr_b16 v[206:207], v239 offset:1024
    ds_read_b128 v[208:211], v227 offset:0
    ds_read_b128 v[212:215], v227 offset:4096
    ds_read_b64_tr_b16 v[216:217], v236 offset:4096
    ds_read_b64_tr_b16 v[218:219], v236 offset:5120
    ds_read_b64_tr_b16 v[220:221], v239 offset:4096
    ds_read_b64_tr_b16 v[222:223], v239 offset:5120
    s_waitcnt lgkmcnt(6)
    v_mfma_f32_32x32x16_bf16 v[128:143], v[200:203], v[192:195], 0
    v_mfma_f32_32x32x16_bf16 v[144:159], v[200:203], v[196:199], 0
    v_mfma_f32_32x32x16_bf16 v[160:175], v[204:207], v[192:195], 0
    v_mfma_f32_32x32x16_bf16 v[176:191], v[204:207], v[196:199], 0
    ds_read_b128 v[192:195], v230 offset:0
    ds_read_b128 v[196:199], v230 offset:4096
    ds_read_b64_tr_b16 v[200:201], v236 offset:8192
    ds_read_b64_tr_b16 v[202:203], v236 offset:9216
    ds_read_b64_tr_b16 v[204:205], v239 offset:8192
    ds_read_b64_tr_b16 v[206:207], v239 offset:9216
    s_waitcnt lgkmcnt(6)
    v_mfma_f32_32x32x16_bf16 v[128:143], v[216:219], v[208:211], v[128:143]
    v_mfma_f32_32x32x16_bf16 v[144:159], v[216:219], v[212:215], v[144:159]
    v_mfma_f32_32x32x16_bf16 v[160:175], v[220:223], v[208:211], v[160:175]
    v_mfma_f32_32x32x16_bf16 v[176:191], v[220:223], v[212:215], v[176:191]
    ds_read_b128 v[208:211], v233 offset:0
    ds_read_b128 v[212:215], v233 offset:4096
    ds_read_b64_tr_b16 v[216:217], v236 offset:12288
    ds_read_b64_tr_b16 v[218:219], v236 offset:13312
    ds_read_b64_tr_b16 v[220:221], v239 offset:12288
    ds_read_b64_tr_b16 v[222:223], v239 offset:13312
    s_waitcnt lgkmcnt(6)
    v_mfma_f32_32x32x16_bf16 v[128:143], v[200:203], v[192:195], v[128:143]
    v_mfma_f32_32x32x16_bf16 v[144:159], v[200:203], v[196:199], v[144:159]
    v_mfma_f32_32x32x16_bf16 v[160:175], v[204:207], v[192:195], v[160:175]
    v_mfma_f32_32x32x16_bf16 v[176:191], v[204:207], v[196:199], v[176:191]
    s_waitcnt vmcnt(11) lgkmcnt(0)
    s_barrier
    s_add_u32 m0, s50, 0
    s_add_u32 s54, s48, 384
    buffer_load_dwordx4 v242, s[4:7], s54 offen lds
    s_add_u32 m0, s50, 4096
    s_add_u32 s54, s48, 33152
    buffer_load_dwordx4 v242, s[4:7], s54 offen lds
    s_add_u32 m0, s50, 8192
    s_add_u32 s54, s48, 65920
    buffer_load_dwordx4 v242, s[4:7], s54 offen lds
    s_add_u32 m0, s50, 12288
    s_add_u32 s54, s48, 98688
    buffer_load_dwordx4 v242, s[4:7], s54 offen lds
    s_add_u32 m0, s50, 16384
    s_add_u32 s54, s49, 688128
    buffer_load_dwordx4 v243, s[24:27], s54 offen lds
    s_add_u32 m0, s50, 20480
    s_add_u32 s54, s49, 745472
    buffer_load_dwordx4 v243, s[24:27], s54 offen lds
    s_add_u32 m0, s50, 24576
    s_add_u32 s54, s49, 802816
    buffer_load_dwordx4 v243, s[24:27], s54 offen lds
    s_add_u32 m0, s50, 28672
    s_add_u32 s54, s49, 860160
    buffer_load_dwordx4 v243, s[24:27], s54 offen lds
    ds_read_b128 v[192:195], v224 offset:32768
    ds_read_b128 v[196:199], v224 offset:36864
    ds_read_b64_tr_b16 v[200:201], v236 offset:32768
    ds_read_b64_tr_b16 v[202:203], v236 offset:33792
    ds_read_b64_tr_b16 v[204:205], v239 offset:32768
    ds_read_b64_tr_b16 v[206:207], v239 offset:33792
    v_mfma_f32_32x32x16_bf16 v[128:143], v[216:219], v[208:211], v[128:143]
    v_mfma_f32_32x32x16_bf16 v[144:159], v[216:219], v[212:215], v[144:159]
    v_mfma_f32_32x32x16_bf16 v[160:175], v[220:223], v[208:211], v[160:175]
    v_mfma_f32_32x32x16_bf16 v[176:191], v[220:223], v[212:215], v[176:191]
    ds_read_b128 v[208:211], v227 offset:32768
    ds_read_b128 v[212:215], v227 offset:36864
    ds_read_b64_tr_b16 v[216:217], v236 offset:36864
    ds_read_b64_tr_b16 v[218:219], v236 offset:37888
    ds_read_b64_tr_b16 v[220:221], v239 offset:36864
    ds_read_b64_tr_b16 v[222:223], v239 offset:37888
    s_waitcnt lgkmcnt(6)
    v_mfma_f32_32x32x16_bf16 v[128:143], v[200:203], v[192:195], v[128:143]
    v_mfma_f32_32x32x16_bf16 v[144:159], v[200:203], v[196:199], v[144:159]
    v_mfma_f32_32x32x16_bf16 v[160:175], v[204:207], v[192:195], v[160:175]
    v_mfma_f32_32x32x16_bf16 v[176:191], v[204:207], v[196:199], v[176:191]
    ds_read_b128 v[192:195], v230 offset:32768
    ds_read_b128 v[196:199], v230 offset:36864
    ds_read_b64_tr_b16 v[200:201], v236 offset:40960
    ds_read_b64_tr_b16 v[202:203], v236 offset:41984
    ds_read_b64_tr_b16 v[204:205], v239 offset:40960
    ds_read_b64_tr_b16 v[206:207], v239 offset:41984
    s_waitcnt lgkmcnt(6)
    v_mfma_f32_32x32x16_bf16 v[128:143], v[216:219], v[208:211], v[128:143]
    v_mfma_f32_32x32x16_bf16 v[144:159], v[216:219], v[212:215], v[144:159]
    v_mfma_f32_32x32x16_bf16 v[160:175], v[220:223], v[208:211], v[160:175]
    v_mfma_f32_32x32x16_bf16 v[176:191], v[220:223], v[212:215], v[176:191]
    ds_read_b128 v[208:211], v233 offset:32768
    ds_read_b128 v[212:215], v233 offset:36864
    ds_read_b64_tr_b16 v[216:217], v236 offset:45056
    ds_read_b64_tr_b16 v[218:219], v236 offset:46080
    ds_read_b64_tr_b16 v[220:221], v239 offset:45056
    ds_read_b64_tr_b16 v[222:223], v239 offset:46080
    s_waitcnt lgkmcnt(6)
    v_mfma_f32_32x32x16_bf16 v[128:143], v[200:203], v[192:195], v[128:143]
    v_mfma_f32_32x32x16_bf16 v[144:159], v[200:203], v[196:199], v[144:159]
    v_mfma_f32_32x32x16_bf16 v[160:175], v[204:207], v[192:195], v[160:175]
    v_mfma_f32_32x32x16_bf16 v[176:191], v[204:207], v[196:199], v[176:191]
    s_waitcnt vmcnt(11) lgkmcnt(0)
    s_barrier
    s_add_u32 m0, s50, 32768
    s_add_u32 s54, s48, 512
    buffer_load_dwordx4 v242, s[4:7], s54 offen lds
    s_add_u32 m0, s50, 36864
    s_add_u32 s54, s48, 33280
    buffer_load_dwordx4 v242, s[4:7], s54 offen lds
    s_add_u32 m0, s50, 40960
    s_add_u32 s54, s48, 66048
    buffer_load_dwordx4 v242, s[4:7], s54 offen lds
    s_add_u32 m0, s50, 45056
    s_add_u32 s54, s48, 98816
    buffer_load_dwordx4 v242, s[4:7], s54 offen lds
    s_add_u32 m0, s50, 49152
    s_add_u32 s54, s49, 917504
    buffer_load_dwordx4 v243, s[24:27], s54 offen lds
    s_add_u32 m0, s50, 53248
    s_add_u32 s54, s49, 974848
    buffer_load_dwordx4 v243, s[24:27], s54 offen lds
    s_add_u32 m0, s50, 57344
    s_add_u32 s54, s49, 1032192
    buffer_load_dwordx4 v243, s[24:27], s54 offen lds
    s_add_u32 m0, s50, 61440
    s_add_u32 s54, s49, 1089536
    buffer_load_dwordx4 v243, s[24:27], s54 offen lds
    ds_read_b128 v[192:195], v225 offset:0
    ds_read_b128 v[196:199], v225 offset:4096
    ds_read_b64_tr_b16 v[200:201], v237 offset:0
    ds_read_b64_tr_b16 v[202:203], v237 offset:1024
    ds_read_b64_tr_b16 v[204:205], v240 offset:0
    ds_read_b64_tr_b16 v[206:207], v240 offset:1024
    v_mfma_f32_32x32x16_bf16 v[128:143], v[216:219], v[208:211], v[128:143]
    v_mfma_f32_32x32x16_bf16 v[144:159], v[216:219], v[212:215], v[144:159]
    v_mfma_f32_32x32x16_bf16 v[160:175], v[220:223], v[208:211], v[160:175]
    v_mfma_f32_32x32x16_bf16 v[176:191], v[220:223], v[212:215], v[176:191]
    ds_read_b128 v[208:211], v228 offset:0
    ds_read_b128 v[212:215], v228 offset:4096
    ds_read_b64_tr_b16 v[216:217], v237 offset:4096
    ds_read_b64_tr_b16 v[218:219], v237 offset:5120
    ds_read_b64_tr_b16 v[220:221], v240 offset:4096
    ds_read_b64_tr_b16 v[222:223], v240 offset:5120
    s_waitcnt lgkmcnt(6)
    v_mfma_f32_32x32x16_bf16 v[128:143], v[200:203], v[192:195], v[128:143]
    v_mfma_f32_32x32x16_bf16 v[144:159], v[200:203], v[196:199], v[144:159]
    v_mfma_f32_32x32x16_bf16 v[160:175], v[204:207], v[192:195], v[160:175]
    v_mfma_f32_32x32x16_bf16 v[176:191], v[204:207], v[196:199], v[176:191]
    ds_read_b128 v[192:195], v231 offset:0
    ds_read_b128 v[196:199], v231 offset:4096
    ds_read_b64_tr_b16 v[200:201], v237 offset:8192
    ds_read_b64_tr_b16 v[202:203], v237 offset:9216
    ds_read_b64_tr_b16 v[204:205], v240 offset:8192
    ds_read_b64_tr_b16 v[206:207], v240 offset:9216
    s_waitcnt lgkmcnt(6)
    v_mfma_f32_32x32x16_bf16 v[128:143], v[216:219], v[208:211], v[128:143]
    v_mfma_f32_32x32x16_bf16 v[144:159], v[216:219], v[212:215], v[144:159]
    v_mfma_f32_32x32x16_bf16 v[160:175], v[220:223], v[208:211], v[160:175]
    v_mfma_f32_32x32x16_bf16 v[176:191], v[220:223], v[212:215], v[176:191]
    ds_read_b128 v[208:211], v234 offset:0
    ds_read_b128 v[212:215], v234 offset:4096
    ds_read_b64_tr_b16 v[216:217], v237 offset:12288
    ds_read_b64_tr_b16 v[218:219], v237 offset:13312
    ds_read_b64_tr_b16 v[220:221], v240 offset:12288
    ds_read_b64_tr_b16 v[222:223], v240 offset:13312
    s_waitcnt lgkmcnt(6)
    v_mfma_f32_32x32x16_bf16 v[128:143], v[200:203], v[192:195], v[128:143]
    v_mfma_f32_32x32x16_bf16 v[144:159], v[200:203], v[196:199], v[144:159]
    v_mfma_f32_32x32x16_bf16 v[160:175], v[204:207], v[192:195], v[160:175]
    v_mfma_f32_32x32x16_bf16 v[176:191], v[204:207], v[196:199], v[176:191]
    s_waitcnt vmcnt(8) lgkmcnt(0)
    s_barrier
    s_cmp_lg_u32 s3, 0
    s_cbranch_scc1 W0_1
    s_and_b32 s53, s2, 1
    s_lshl_b32 s53, s53, 7
    v_mov_b32 v246, s53
    buffer_load_dword v247, v246, s[20:23], 0 offen sc1

W0_1:
    s_add_u32 m0, s50, 65536
    s_add_u32 s54, s48, 640
    buffer_load_dwordx4 v242, s[4:7], s54 offen lds
    s_add_u32 m0, s50, 69632
    s_add_u32 s54, s48, 33408
    buffer_load_dwordx4 v242, s[4:7], s54 offen lds
    s_add_u32 m0, s50, 73728
    s_add_u32 s54, s48, 66176
    buffer_load_dwordx4 v242, s[4:7], s54 offen lds
    s_add_u32 m0, s50, 77824
    s_add_u32 s54, s48, 98944
    buffer_load_dwordx4 v242, s[4:7], s54 offen lds
    s_add_u32 m0, s50, 81920
    s_add_u32 s54, s49, 1146880
    buffer_load_dwordx4 v243, s[24:27], s54 offen lds
    s_add_u32 m0, s50, 86016
    s_add_u32 s54, s49, 1204224
    buffer_load_dwordx4 v243, s[24:27], s54 offen lds
    s_add_u32 m0, s50, 90112
    s_add_u32 s54, s49, 1261568
    buffer_load_dwordx4 v243, s[24:27], s54 offen lds
    s_add_u32 m0, s50, 94208
    s_add_u32 s54, s49, 1318912
    buffer_load_dwordx4 v243, s[24:27], s54 offen lds
    ds_read_b128 v[192:195], v224 offset:0
    ds_read_b128 v[196:199], v224 offset:4096
    ds_read_b64_tr_b16 v[200:201], v236 offset:0
    ds_read_b64_tr_b16 v[202:203], v236 offset:1024
    ds_read_b64_tr_b16 v[204:205], v239 offset:0
    ds_read_b64_tr_b16 v[206:207], v239 offset:1024
    v_mfma_f32_32x32x16_bf16 v[128:143], v[216:219], v[208:211], v[128:143]
    v_mfma_f32_32x32x16_bf16 v[144:159], v[216:219], v[212:215], v[144:159]
    v_mfma_f32_32x32x16_bf16 v[160:175], v[220:223], v[208:211], v[160:175]
    v_mfma_f32_32x32x16_bf16 v[176:191], v[220:223], v[212:215], v[176:191]
    ds_read_b128 v[208:211], v227 offset:0
    ds_read_b128 v[212:215], v227 offset:4096
    ds_read_b64_tr_b16 v[216:217], v236 offset:4096
    ds_read_b64_tr_b16 v[218:219], v236 offset:5120
    ds_read_b64_tr_b16 v[220:221], v239 offset:4096
    ds_read_b64_tr_b16 v[222:223], v239 offset:5120
    s_waitcnt lgkmcnt(6)
    v_mfma_f32_32x32x16_bf16 v[128:143], v[200:203], v[192:195], v[128:143]
    v_mfma_f32_32x32x16_bf16 v[144:159], v[200:203], v[196:199], v[144:159]
    v_mfma_f32_32x32x16_bf16 v[160:175], v[204:207], v[192:195], v[160:175]
    v_mfma_f32_32x32x16_bf16 v[176:191], v[204:207], v[196:199], v[176:191]
    ds_read_b128 v[192:195], v230 offset:0
    ds_read_b128 v[196:199], v230 offset:4096
    ds_read_b64_tr_b16 v[200:201], v236 offset:8192
    ds_read_b64_tr_b16 v[202:203], v236 offset:9216
    ds_read_b64_tr_b16 v[204:205], v239 offset:8192
    ds_read_b64_tr_b16 v[206:207], v239 offset:9216
    s_waitcnt lgkmcnt(6)
    v_mfma_f32_32x32x16_bf16 v[128:143], v[216:219], v[208:211], v[128:143]
    v_mfma_f32_32x32x16_bf16 v[144:159], v[216:219], v[212:215], v[144:159]
    v_mfma_f32_32x32x16_bf16 v[160:175], v[220:223], v[208:211], v[160:175]
    v_mfma_f32_32x32x16_bf16 v[176:191], v[220:223], v[212:215], v[176:191]
    ds_read_b128 v[208:211], v233 offset:0
    ds_read_b128 v[212:215], v233 offset:4096
    ds_read_b64_tr_b16 v[216:217], v236 offset:12288
    ds_read_b64_tr_b16 v[218:219], v236 offset:13312
    ds_read_b64_tr_b16 v[220:221], v239 offset:12288
    ds_read_b64_tr_b16 v[222:223], v239 offset:13312
    s_waitcnt lgkmcnt(6)
    v_mfma_f32_32x32x16_bf16 v[128:143], v[200:203], v[192:195], v[128:143]
    v_mfma_f32_32x32x16_bf16 v[144:159], v[200:203], v[196:199], v[144:159]
    v_mfma_f32_32x32x16_bf16 v[160:175], v[204:207], v[192:195], v[160:175]
    v_mfma_f32_32x32x16_bf16 v[176:191], v[204:207], v[196:199], v[176:191]
    s_waitcnt vmcnt(8) lgkmcnt(0)
    s_waitcnt vmcnt(24)
    s_barrier
    s_add_u32 m0, s50, 0
    s_add_u32 s54, s48, 768
    buffer_load_dwordx4 v242, s[4:7], s54 offen lds
    s_add_u32 m0, s50, 4096
    s_add_u32 s54, s48, 33536
    buffer_load_dwordx4 v242, s[4:7], s54 offen lds
    s_add_u32 m0, s50, 8192
    s_add_u32 s54, s48, 66304
    buffer_load_dwordx4 v242, s[4:7], s54 offen lds
    s_add_u32 m0, s50, 12288
    s_add_u32 s54, s48, 99072
    buffer_load_dwordx4 v242, s[4:7], s54 offen lds
    s_add_u32 m0, s50, 16384
    s_add_u32 s54, s49, 1376256
    buffer_load_dwordx4 v243, s[24:27], s54 offen lds
    s_add_u32 m0, s50, 20480
    s_add_u32 s54, s49, 1433600
    buffer_load_dwordx4 v243, s[24:27], s54 offen lds
    s_add_u32 m0, s50, 24576
    s_add_u32 s54, s49, 1490944
    buffer_load_dwordx4 v243, s[24:27], s54 offen lds
    s_add_u32 m0, s50, 28672
    s_add_u32 s54, s49, 1548288
    buffer_load_dwordx4 v243, s[24:27], s54 offen lds
    s_cmp_lg_u32 s3, 0
    s_cbranch_scc1 W0_2
    s_mov_b32 s62, 0
    s_waitcnt vmcnt(16)
    s_branch FZCK_5
FZ_3:
    buffer_load_dword v247, v246, s[20:23], 0 offen sc1
    s_waitcnt vmcnt(0)
FZCK_5:
    v_cmp_ne_u32 vcc, 0, v247
    s_add_u32 s62, s62, 1
    s_cmp_eq_u64 vcc, -1
    s_cbranch_scc1 FZOK_4
    s_cmp_ge_u32 s62, 32768
    s_cbranch_scc1 FZOK_4
    s_sleep 4
    s_branch FZ_3

FZOK_4:
    s_lshl_b32 s53, s58, 10
    s_lshl_b32 s54, s59, 2
    s_add_u32 s53, s53, s54
    s_add_u32 s53, s53, 13631488

    v_lshlrev_b32 v246, 7, v1
    v_mov_b32 v247, 1
    v_cmp_gt_u32 vcc, 8, v1
    s_and_saveexec_b64 s[62:63], vcc
    buffer_store_dword v247, v246, s[32:35], s53 offen sc1
    s_mov_b64 exec, s[62:63]

W0_2:
    ds_read_b128 v[192:195], v224 offset:32768
    ds_read_b128 v[196:199], v224 offset:36864
    ds_read_b64_tr_b16 v[200:201], v236 offset:32768
    ds_read_b64_tr_b16 v[202:203], v236 offset:33792
    ds_read_b64_tr_b16 v[204:205], v239 offset:32768
    ds_read_b64_tr_b16 v[206:207], v239 offset:33792
    v_mfma_f32_32x32x16_bf16 v[128:143], v[216:219], v[208:211], v[128:143]
    v_mfma_f32_32x32x16_bf16 v[144:159], v[216:219], v[212:215], v[144:159]
    v_mfma_f32_32x32x16_bf16 v[160:175], v[220:223], v[208:211], v[160:175]
    v_mfma_f32_32x32x16_bf16 v[176:191], v[220:223], v[212:215], v[176:191]
    ds_read_b128 v[208:211], v227 offset:32768
    ds_read_b128 v[212:215], v227 offset:36864
    ds_read_b64_tr_b16 v[216:217], v236 offset:36864
    ds_read_b64_tr_b16 v[218:219], v236 offset:37888
    ds_read_b64_tr_b16 v[220:221], v239 offset:36864
    ds_read_b64_tr_b16 v[222:223], v239 offset:37888
    s_waitcnt lgkmcnt(6)
    v_mfma_f32_32x32x16_bf16 v[128:143], v[200:203], v[192:195], v[128:143]
    v_mfma_f32_32x32x16_bf16 v[144:159], v[200:203], v[196:199], v[144:159]
    v_mfma_f32_32x32x16_bf16 v[160:175], v[204:207], v[192:195], v[160:175]
    v_mfma_f32_32x32x16_bf16 v[176:191], v[204:207], v[196:199], v[176:191]
    ds_read_b128 v[192:195], v230 offset:32768
    ds_read_b128 v[196:199], v230 offset:36864
    ds_read_b64_tr_b16 v[200:201], v236 offset:40960
    ds_read_b64_tr_b16 v[202:203], v236 offset:41984
    ds_read_b64_tr_b16 v[204:205], v239 offset:40960
    ds_read_b64_tr_b16 v[206:207], v239 offset:41984
    s_waitcnt lgkmcnt(6)
    v_mfma_f32_32x32x16_bf16 v[128:143], v[216:219], v[208:211], v[128:143]
    v_mfma_f32_32x32x16_bf16 v[144:159], v[216:219], v[212:215], v[144:159]
    v_mfma_f32_32x32x16_bf16 v[160:175], v[220:223], v[208:211], v[160:175]
    v_mfma_f32_32x32x16_bf16 v[176:191], v[220:223], v[212:215], v[176:191]
    ds_read_b128 v[208:211], v233 offset:32768
    ds_read_b128 v[212:215], v233 offset:36864
    ds_read_b64_tr_b16 v[216:217], v236 offset:45056
    ds_read_b64_tr_b16 v[218:219], v236 offset:46080
    ds_read_b64_tr_b16 v[220:221], v239 offset:45056
    ds_read_b64_tr_b16 v[222:223], v239 offset:46080
    s_waitcnt lgkmcnt(6)
    v_mfma_f32_32x32x16_bf16 v[128:143], v[200:203], v[192:195], v[128:143]
    v_mfma_f32_32x32x16_bf16 v[144:159], v[200:203], v[196:199], v[144:159]
    v_mfma_f32_32x32x16_bf16 v[160:175], v[204:207], v[192:195], v[160:175]
    v_mfma_f32_32x32x16_bf16 v[176:191], v[204:207], v[196:199], v[176:191]
    s_waitcnt vmcnt(8) lgkmcnt(0)
    s_barrier
    s_add_u32 m0, s50, 32768
    s_add_u32 s54, s48, 896
    buffer_load_dwordx4 v242, s[4:7], s54 offen lds
    s_add_u32 m0, s50, 36864
    s_add_u32 s54, s48, 33664
    buffer_load_dwordx4 v242, s[4:7], s54 offen lds
    s_add_u32 m0, s50, 40960
    s_add_u32 s54, s48, 66432
    buffer_load_dwordx4 v242, s[4:7], s54 offen lds
    s_add_u32 m0, s50, 45056
    s_add_u32 s54, s48, 99200
    buffer_load_dwordx4 v242, s[4:7], s54 offen lds
    s_add_u32 m0, s50, 49152
    s_add_u32 s54, s49, 1605632
    buffer_load_dwordx4 v243, s[24:27], s54 offen lds
    s_add_u32 m0, s50, 53248
    s_add_u32 s54, s49, 1662976
    buffer_load_dwordx4 v243, s[24:27], s54 offen lds
    s_add_u32 m0, s50, 57344
    s_add_u32 s54, s49, 1720320
    buffer_load_dwordx4 v243, s[24:27], s54 offen lds
    s_add_u32 m0, s50, 61440
    s_add_u32 s54, s49, 1777664
    buffer_load_dwordx4 v243, s[24:27], s54 offen lds
    v_lshlrev_b32 v2, 4, v1
    s_add_u32 s43, s38, s41
    v_add_u32 v3, s43, v2
    v_subrev_u32 v4, 4, v3
    v_subrev_u32 v5, 8, v3
    buffer_load_dwordx4 v[16:19], v3, s[16:19], 0 offen
    buffer_load_dwordx4 v[20:23], v4, s[16:19], 0 offen
    buffer_load_dwordx4 v[24:27], v5, s[16:19], 0 offen
    v_add_u32 v4, 1024, v4
    v_add_u32 v5, 1024, v5
    buffer_load_dwordx4 v[28:31], v3, s[16:19], 0 offen offset:1024
    buffer_load_dwordx4 v[32:35], v4, s[16:19], 0 offen
    buffer_load_dwordx4 v[36:39], v5, s[16:19], 0 offen
    s_lshl_b32 s43, s42, 1
    v_mov_b32 v6, s43
    buffer_load_ushort v40, v6, s[28:31], 0 offen

    s_and_b32 s77, s59, 7
    s_lshl_b32 s77, s77, 3
    s_add_u32 s77, s77, s58
    s_lshl_b32 s77, s77, 7
    s_add_u32 s77, s77, 13656064
    v_and_b32 v248, 3, v1
    v_lshlrev_b32 v248, 2, v248

    buffer_load_dword v249, v248, s[32:35], s77 offen sc1
    ds_read_b128 v[192:195], v225 offset:0
    ds_read_b128 v[196:199], v225 offset:4096
    ds_read_b64_tr_b16 v[200:201], v237 offset:0
    ds_read_b64_tr_b16 v[202:203], v237 offset:1024
    ds_read_b64_tr_b16 v[204:205], v240 offset:0
    ds_read_b64_tr_b16 v[206:207], v240 offset:1024
    v_mfma_f32_32x32x16_bf16 v[128:143], v[216:219], v[208:211], v[128:143]
    v_mfma_f32_32x32x16_bf16 v[144:159], v[216:219], v[212:215], v[144:159]
    v_mfma_f32_32x32x16_bf16 v[160:175], v[220:223], v[208:211], v[160:175]
    v_mfma_f32_32x32x16_bf16 v[176:191], v[220:223], v[212:215], v[176:191]
    ds_read_b128 v[208:211], v228 offset:0
    ds_read_b128 v[212:215], v228 offset:4096
    ds_read_b64_tr_b16 v[216:217], v237 offset:4096
    ds_read_b64_tr_b16 v[218:219], v237 offset:5120
    ds_read_b64_tr_b16 v[220:221], v240 offset:4096
    ds_read_b64_tr_b16 v[222:223], v240 offset:5120
    s_waitcnt lgkmcnt(6)
    v_mfma_f32_32x32x16_bf16 v[128:143], v[200:203], v[192:195], v[128:143]
    v_mfma_f32_32x32x16_bf16 v[144:159], v[200:203], v[196:199], v[144:159]
    v_mfma_f32_32x32x16_bf16 v[160:175], v[204:207], v[192:195], v[160:175]
    v_mfma_f32_32x32x16_bf16 v[176:191], v[204:207], v[196:199], v[176:191]
    ds_read_b128 v[192:195], v231 offset:0
    ds_read_b128 v[196:199], v231 offset:4096
    ds_read_b64_tr_b16 v[200:201], v237 offset:8192
    ds_read_b64_tr_b16 v[202:203], v237 offset:9216
    ds_read_b64_tr_b16 v[204:205], v240 offset:8192
    ds_read_b64_tr_b16 v[206:207], v240 offset:9216
    s_waitcnt lgkmcnt(6)
    v_mfma_f32_32x32x16_bf16 v[128:143], v[216:219], v[208:211], v[128:143]
    v_mfma_f32_32x32x16_bf16 v[144:159], v[216:219], v[212:215], v[144:159]
    v_mfma_f32_32x32x16_bf16 v[160:175], v[220:223], v[208:211], v[160:175]
    v_mfma_f32_32x32x16_bf16 v[176:191], v[220:223], v[212:215], v[176:191]
    ds_read_b128 v[208:211], v234 offset:0
    ds_read_b128 v[212:215], v234 offset:4096
    ds_read_b64_tr_b16 v[216:217], v237 offset:12288
    ds_read_b64_tr_b16 v[218:219], v237 offset:13312
    ds_read_b64_tr_b16 v[220:221], v240 offset:12288
    ds_read_b64_tr_b16 v[222:223], v240 offset:13312
    s_waitcnt lgkmcnt(6)
    v_mfma_f32_32x32x16_bf16 v[128:143], v[200:203], v[192:195], v[128:143]
    v_mfma_f32_32x32x16_bf16 v[144:159], v[200:203], v[196:199], v[144:159]
    v_mfma_f32_32x32x16_bf16 v[160:175], v[204:207], v[192:195], v[160:175]
    v_mfma_f32_32x32x16_bf16 v[176:191], v[204:207], v[196:199], v[176:191]
    s_waitcnt vmcnt(16) lgkmcnt(0)
    s_barrier
    s_mov_b32 s62, 0
    s_waitcnt vmcnt(0)
    s_branch WPCK_8
WP_6:
    buffer_load_dword v249, v248, s[32:35], s77 offen sc1
    s_waitcnt vmcnt(0)
WPCK_8:
    v_cmp_ne_u32 vcc, 0, v249
    s_add_u32 s62, s62, 1
    s_cmp_eq_u64 vcc, -1
    s_cbranch_scc1 WPOK_7
    s_cmp_ge_u32 s62, 32768
    s_cbranch_scc1 WPOK_7
    s_sleep 4
    s_branch WP_6

WPOK_7:
    ds_read_b128 v[192:195], v224 offset:0
    ds_read_b128 v[196:199], v224 offset:4096
    ds_read_b64_tr_b16 v[200:201], v236 offset:0
    ds_read_b64_tr_b16 v[202:203], v236 offset:1024
    ds_read_b64_tr_b16 v[204:205], v239 offset:0
    ds_read_b64_tr_b16 v[206:207], v239 offset:1024
    v_mfma_f32_32x32x16_bf16 v[128:143], v[216:219], v[208:211], v[128:143]
    v_mfma_f32_32x32x16_bf16 v[144:159], v[216:219], v[212:215], v[144:159]
    s_add_u32 s54, s47, 0
    buffer_load_dwordx4 a[0:3], v252, s[32:35], s54 offen
    v_mfma_f32_32x32x16_bf16 v[160:175], v[220:223], v[208:211], v[160:175]
    v_mfma_f32_32x32x16_bf16 v[176:191], v[220:223], v[212:215], v[176:191]
    s_add_u32 s54, s47, 1024
    buffer_load_dwordx4 a[4:7], v252, s[32:35], s54 offen
    ds_read_b128 v[208:211], v227 offset:0
    ds_read_b128 v[212:215], v227 offset:4096
    ds_read_b64_tr_b16 v[216:217], v236 offset:4096
    ds_read_b64_tr_b16 v[218:219], v236 offset:5120
    ds_read_b64_tr_b16 v[220:221], v239 offset:4096
    ds_read_b64_tr_b16 v[222:223], v239 offset:5120
    s_waitcnt lgkmcnt(6)
    v_mfma_f32_32x32x16_bf16 v[128:143], v[200:203], v[192:195], v[128:143]
    v_mfma_f32_32x32x16_bf16 v[144:159], v[200:203], v[196:199], v[144:159]
    s_add_u32 s54, s47, 2048
    buffer_load_dwordx4 a[8:11], v252, s[32:35], s54 offen
    v_mfma_f32_32x32x16_bf16 v[160:175], v[204:207], v[192:195], v[160:175]
    v_mfma_f32_32x32x16_bf16 v[176:191], v[204:207], v[196:199], v[176:191]
    s_add_u32 s54, s47, 3072
    buffer_load_dwordx4 a[12:15], v252, s[32:35], s54 offen
    ds_read_b128 v[192:195], v230 offset:0
    ds_read_b128 v[196:199], v230 offset:4096
    ds_read_b64_tr_b16 v[200:201], v236 offset:8192
    ds_read_b64_tr_b16 v[202:203], v236 offset:9216
    ds_read_b64_tr_b16 v[204:205], v239 offset:8192
    ds_read_b64_tr_b16 v[206:207], v239 offset:9216
    s_waitcnt lgkmcnt(6)
    v_mfma_f32_32x32x16_bf16 v[128:143], v[216:219], v[208:211], v[128:143]
    v_mfma_f32_32x32x16_bf16 v[144:159], v[216:219], v[212:215], v[144:159]
    s_add_u32 s54, s47, 4096
    buffer_load_dwordx4 a[16:19], v252, s[32:35], s54 offen
    v_mfma_f32_32x32x16_bf16 v[160:175], v[220:223], v[208:211], v[160:175]
    v_mfma_f32_32x32x16_bf16 v[176:191], v[220:223], v[212:215], v[176:191]
    s_add_u32 s54, s47, 5120
    buffer_load_dwordx4 a[20:23], v252, s[32:35], s54 offen
    ds_read_b128 v[208:211], v233 offset:0
    ds_read_b128 v[212:215], v233 offset:4096
    ds_read_b64_tr_b16 v[216:217], v236 offset:12288
    ds_read_b64_tr_b16 v[218:219], v236 offset:13312
    ds_read_b64_tr_b16 v[220:221], v239 offset:12288
    ds_read_b64_tr_b16 v[222:223], v239 offset:13312
    s_waitcnt lgkmcnt(6)
    v_mfma_f32_32x32x16_bf16 v[128:143], v[200:203], v[192:195], v[128:143]
    v_mfma_f32_32x32x16_bf16 v[144:159], v[200:203], v[196:199], v[144:159]
    s_add_u32 s54, s47, 6144
    buffer_load_dwordx4 a[24:27], v252, s[32:35], s54 offen
    v_mfma_f32_32x32x16_bf16 v[160:175], v[204:207], v[192:195], v[160:175]
    v_mfma_f32_32x32x16_bf16 v[176:191], v[204:207], v[196:199], v[176:191]
    s_add_u32 s54, s47, 7168
    buffer_load_dwordx4 a[28:31], v252, s[32:35], s54 offen
    s_waitcnt vmcnt(16) lgkmcnt(0)
    s_barrier
    s_lshr_b32 s45, s2, 5
    s_lshl_b32 s45, s45, 3
    s_add_u32 s45, s45, s58
    s_lshl_b32 s45, s45, 7
    s_add_u32 s45, s45, 13631488
    v_and_b32 v244, 31, v1
    v_lshlrev_b32 v244, 2, v244
    buffer_load_dword v245, v244, s[32:35], s45 offen sc1

    ds_read_b128 v[192:195], v224 offset:32768
    ds_read_b128 v[196:199], v224 offset:36864
    ds_read_b64_tr_b16 v[200:201], v236 offset:32768
    ds_read_b64_tr_b16 v[202:203], v236 offset:33792
    ds_read_b64_tr_b16 v[204:205], v239 offset:32768
    ds_read_b64_tr_b16 v[206:207], v239 offset:33792
    v_mfma_f32_32x32x16_bf16 v[128:143], v[216:219], v[208:211], v[128:143]
    v_mfma_f32_32x32x16_bf16 v[144:159], v[216:219], v[212:215], v[144:159]
    s_add_u32 s54, s47, 32768
    buffer_load_dwordx4 a[32:35], v252, s[32:35], s54 offen
    v_mfma_f32_32x32x16_bf16 v[160:175], v[220:223], v[208:211], v[160:175]
    v_mfma_f32_32x32x16_bf16 v[176:191], v[220:223], v[212:215], v[176:191]
    s_add_u32 s54, s47, 33792
    buffer_load_dwordx4 a[36:39], v252, s[32:35], s54 offen
    ds_read_b128 v[208:211], v227 offset:32768
    ds_read_b128 v[212:215], v227 offset:36864
    ds_read_b64_tr_b16 v[216:217], v236 offset:36864
    ds_read_b64_tr_b16 v[218:219], v236 offset:37888
    ds_read_b64_tr_b16 v[220:221], v239 offset:36864
    ds_read_b64_tr_b16 v[222:223], v239 offset:37888
    s_waitcnt lgkmcnt(6)
    v_mfma_f32_32x32x16_bf16 v[128:143], v[200:203], v[192:195], v[128:143]
    v_mfma_f32_32x32x16_bf16 v[144:159], v[200:203], v[196:199], v[144:159]
    s_add_u32 s54, s47, 34816
    buffer_load_dwordx4 a[40:43], v252, s[32:35], s54 offen
    v_mfma_f32_32x32x16_bf16 v[160:175], v[204:207], v[192:195], v[160:175]
    v_mfma_f32_32x32x16_bf16 v[176:191], v[204:207], v[196:199], v[176:191]
    s_add_u32 s54, s47, 35840
    buffer_load_dwordx4 a[44:47], v252, s[32:35], s54 offen
    ds_read_b128 v[192:195], v230 offset:32768
    ds_read_b128 v[196:199], v230 offset:36864
    ds_read_b64_tr_b16 v[200:201], v236 offset:40960
    ds_read_b64_tr_b16 v[202:203], v236 offset:41984
    ds_read_b64_tr_b16 v[204:205], v239 offset:40960
    ds_read_b64_tr_b16 v[206:207], v239 offset:41984
    s_waitcnt lgkmcnt(6)
    v_mfma_f32_32x32x16_bf16 v[128:143], v[216:219], v[208:211], v[128:143]
    v_mfma_f32_32x32x16_bf16 v[144:159], v[216:219], v[212:215], v[144:159]
    s_add_u32 s54, s47, 36864
    buffer_load_dwordx4 a[48:51], v252, s[32:35], s54 offen
    v_mfma_f32_32x32x16_bf16 v[160:175], v[220:223], v[208:211], v[160:175]
    v_mfma_f32_32x32x16_bf16 v[176:191], v[220:223], v[212:215], v[176:191]
    s_add_u32 s54, s47, 37888
    buffer_load_dwordx4 a[52:55], v252, s[32:35], s54 offen
    ds_read_b128 v[208:211], v233 offset:32768
    ds_read_b128 v[212:215], v233 offset:36864
    ds_read_b64_tr_b16 v[216:217], v236 offset:45056
    ds_read_b64_tr_b16 v[218:219], v236 offset:46080
    ds_read_b64_tr_b16 v[220:221], v239 offset:45056
    ds_read_b64_tr_b16 v[222:223], v239 offset:46080
    s_waitcnt lgkmcnt(6)
    v_mfma_f32_32x32x16_bf16 v[128:143], v[200:203], v[192:195], v[128:143]
    v_mfma_f32_32x32x16_bf16 v[144:159], v[200:203], v[196:199], v[144:159]
    s_add_u32 s54, s47, 38912
    buffer_load_dwordx4 a[56:59], v252, s[32:35], s54 offen
    v_mfma_f32_32x32x16_bf16 v[160:175], v[204:207], v[192:195], v[160:175]
    v_mfma_f32_32x32x16_bf16 v[176:191], v[204:207], v[196:199], v[176:191]
    s_add_u32 s54, s47, 39936
    buffer_load_dwordx4 a[60:63], v252, s[32:35], s54 offen
    s_waitcnt lgkmcnt(0)
    v_mfma_f32_32x32x16_bf16 v[128:143], v[216:219], v[208:211], v[128:143]
    v_mfma_f32_32x32x16_bf16 v[144:159], v[216:219], v[212:215], v[144:159]
    s_add_u32 s54, s47, 65536
    buffer_load_dwordx4 a[64:67], v252, s[32:35], s54 offen
    v_mfma_f32_32x32x16_bf16 v[160:175], v[220:223], v[208:211], v[160:175]
    v_mfma_f32_32x32x16_bf16 v[176:191], v[220:223], v[212:215], v[176:191]
    s_add_u32 s54, s47, 66560
    buffer_load_dwordx4 a[68:71], v252, s[32:35], s54 offen
    s_barrier
    s_waitcnt vmcnt(10)
    v_cmp_ne_u32 vcc, 0, v245
    s_mov_b32 s46, 0
    s_cmp_eq_u64 vcc, -1
    s_cbranch_scc0 UNR_9
    s_mov_b32 s46, 1

    v_lshlrev_b32 v2, 4, v1
    s_add_u32 s43, s40, s41
    s_add_u32 m0, s43, 512
    s_add_u32 s44, s38, s41
    s_add_u32 s44, s44, 8388608
    buffer_load_dwordx4 v2, s[32:35], s44 offen lds
    s_add_u32 m0, s43, 1536
    s_add_u32 s44, s44, 1024
    buffer_load_dwordx4 v2, s[32:35], s44 offen lds

UNR_9:
    s_nop 15
    v_and_b32 v2, 31, v1
    v_lshlrev_b32 v2, 7, v2
    v_lshrrev_b32 v3, 5, v1
    v_and_b32 v4, 7, v1
    v_xor_b32 v3, v3, v4
    v_lshl_add_u32 v2, v3, 4, v2
    s_lshl_b32 s53, s3, 13
    v_add_u32 v2, s53, v2
    v_xor_b32 v3, 32, v2
    v_xor_b32 v4, 64, v2
    v_xor_b32 v5, 96, v2
    v_lshrrev_b32 v6, 3, v1
    v_and_b32 v7, 7, v1
    v_xor_b32 v8, v7, v6
    v_lshlrev_b32 v8, 4, v8
    v_lshl_add_u32 v8, v6, 7, v8
    v_add_u32 v8, s53, v8
    v_mul_u32_u24 v9, 3584, v6
    v_lshl_add_u32 v9, v7, 4, v9
    s_lshl_b32 s53, s51, 6
    s_add_u32 s53, s53, s55
    s_mul_i32 s53, s53, 3584
    s_lshl_b32 s54, s52, 7
    s_add_u32 s53, s53, s54
    s_add_u32 s53, s53, s56
    s_add_u32 s53, s53, 0

    v_max_f32 v128, 0, v128
    v_max_f32 v129, 0, v129
    v_max_f32 v130, 0, v130
    v_max_f32 v131, 0, v131
    v_max_f32 v132, 0, v132
    v_max_f32 v133, 0, v133
    v_max_f32 v134, 0, v134
    v_max_f32 v135, 0, v135
    v_cvt_pk_bf16_f32 v192, v128, v129
    v_cvt_pk_bf16_f32 v193, v130, v131
    v_cvt_pk_bf16_f32 v194, v132, v133
    v_cvt_pk_bf16_f32 v195, v134, v135
    s_nop 1
    v_permlane32_swap_b32 v192, v194
    v_permlane32_swap_b32 v193, v195
    ds_write_b128 v2, v[192:195] offset:0
    s_add_u32 s54, s47, 67584
    buffer_load_dwordx4 a[72:75], v252, s[32:35], s54 offen
    v_max_f32 v136, 0, v136
    v_max_f32 v137, 0, v137
    v_max_f32 v138, 0, v138
    v_max_f32 v139, 0, v139
    v_max_f32 v140, 0, v140
    v_max_f32 v141, 0, v141
    v_max_f32 v142, 0, v142
    v_max_f32 v143, 0, v143
    v_cvt_pk_bf16_f32 v196, v136, v137
    v_cvt_pk_bf16_f32 v197, v138, v139
    v_cvt_pk_bf16_f32 v198, v140, v141
    v_cvt_pk_bf16_f32 v199, v142, v143
    s_nop 1
    v_permlane32_swap_b32 v196, v198
    v_permlane32_swap_b32 v197, v199
    ds_write_b128 v3, v[196:199] offset:0
    s_add_u32 s54, s47, 68608
    buffer_load_dwordx4 a[76:79], v252, s[32:35], s54 offen
    v_max_f32 v144, 0, v144
    v_max_f32 v145, 0, v145
    v_max_f32 v146, 0, v146
    v_max_f32 v147, 0, v147
    v_max_f32 v148, 0, v148
    v_max_f32 v149, 0, v149
    v_max_f32 v150, 0, v150
    v_max_f32 v151, 0, v151
    v_cvt_pk_bf16_f32 v200, v144, v145
    v_cvt_pk_bf16_f32 v201, v146, v147
    v_cvt_pk_bf16_f32 v202, v148, v149
    v_cvt_pk_bf16_f32 v203, v150, v151
    s_nop 1
    v_permlane32_swap_b32 v200, v202
    v_permlane32_swap_b32 v201, v203
    ds_write_b128 v2, v[200:203] offset:4096
    s_add_u32 s54, s47, 69632
    buffer_load_dwordx4 a[80:83], v252, s[32:35], s54 offen
    v_max_f32 v152, 0, v152
    v_max_f32 v153, 0, v153
    v_max_f32 v154, 0, v154
    v_max_f32 v155, 0, v155
    v_max_f32 v156, 0, v156
    v_max_f32 v157, 0, v157
    v_max_f32 v158, 0, v158
    v_max_f32 v159, 0, v159
    v_cvt_pk_bf16_f32 v204, v152, v153
    v_cvt_pk_bf16_f32 v205, v154, v155
    v_cvt_pk_bf16_f32 v206, v156, v157
    v_cvt_pk_bf16_f32 v207, v158, v159
    s_nop 1
    v_permlane32_swap_b32 v204, v206
    v_permlane32_swap_b32 v205, v207
    ds_write_b128 v3, v[204:207] offset:4096
    s_add_u32 s54, s47, 70656
    buffer_load_dwordx4 a[84:87], v252, s[32:35], s54 offen
    v_max_f32 v160, 0, v160
    v_max_f32 v161, 0, v161
    v_max_f32 v162, 0, v162
    v_max_f32 v163, 0, v163
    v_max_f32 v164, 0, v164
    v_max_f32 v165, 0, v165
    v_max_f32 v166, 0, v166
    v_max_f32 v167, 0, v167
    v_cvt_pk_bf16_f32 v208, v160, v161
    v_cvt_pk_bf16_f32 v209, v162, v163
    v_cvt_pk_bf16_f32 v210, v164, v165
    v_cvt_pk_bf16_f32 v211, v166, v167
    s_nop 1
    v_permlane32_swap_b32 v208, v210
    v_permlane32_swap_b32 v209, v211
    ds_write_b128 v4, v[208:211] offset:0
    s_add_u32 s54, s47, 71680
    buffer_load_dwordx4 a[88:91], v252, s[32:35], s54 offen
    v_max_f32 v168, 0, v168
    v_max_f32 v169, 0, v169
    v_max_f32 v170, 0, v170
    v_max_f32 v171, 0, v171
    v_max_f32 v172, 0, v172
    v_max_f32 v173, 0, v173
    v_max_f32 v174, 0, v174
    v_max_f32 v175, 0, v175
    v_cvt_pk_bf16_f32 v212, v168, v169
    v_cvt_pk_bf16_f32 v213, v170, v171
    v_cvt_pk_bf16_f32 v214, v172, v173
    v_cvt_pk_bf16_f32 v215, v174, v175
    s_nop 1
    v_permlane32_swap_b32 v212, v214
    v_permlane32_swap_b32 v213, v215
    ds_write_b128 v5, v[212:215] offset:0
    s_add_u32 s54, s47, 72704
    buffer_load_dwordx4 a[92:95], v252, s[32:35], s54 offen
    v_max_f32 v176, 0, v176
    v_max_f32 v177, 0, v177
    v_max_f32 v178, 0, v178
    v_max_f32 v179, 0, v179
    v_max_f32 v180, 0, v180
    v_max_f32 v181, 0, v181
    v_max_f32 v182, 0, v182
    v_max_f32 v183, 0, v183
    v_cvt_pk_bf16_f32 v216, v176, v177
    v_cvt_pk_bf16_f32 v217, v178, v179
    v_cvt_pk_bf16_f32 v218, v180, v181
    v_cvt_pk_bf16_f32 v219, v182, v183
    s_nop 1
    v_permlane32_swap_b32 v216, v218
    v_permlane32_swap_b32 v217, v219
    ds_write_b128 v4, v[216:219] offset:4096
    s_add_u32 s54, s47, 98304
    buffer_load_dwordx4 a[96:99], v252, s[32:35], s54 offen
    v_max_f32 v184, 0, v184
    v_max_f32 v185, 0, v185
    v_max_f32 v186, 0, v186
    v_max_f32 v187, 0, v187
    v_max_f32 v188, 0, v188
    v_max_f32 v189, 0, v189
    v_max_f32 v190, 0, v190
    v_max_f32 v191, 0, v191
    v_cvt_pk_bf16_f32 v220, v184, v185
    v_cvt_pk_bf16_f32 v221, v186, v187
    v_cvt_pk_bf16_f32 v222, v188, v189
    v_cvt_pk_bf16_f32 v223, v190, v191
    s_nop 1
    v_permlane32_swap_b32 v220, v222
    v_permlane32_swap_b32 v221, v223
    ds_write_b128 v5, v[220:223] offset:4096
    s_add_u32 s54, s47, 99328
    buffer_load_dwordx4 a[100:103], v252, s[32:35], s54 offen
    s_waitcnt lgkmcnt(0)
    ds_read_b128 v[128:131], v8 offset:0
    ds_read_b128 v[132:135], v8 offset:1024
    ds_read_b128 v[136:139], v8 offset:2048
    ds_read_b128 v[140:143], v8 offset:3072
    ds_read_b128 v[144:147], v8 offset:4096
    ds_read_b128 v[148:151], v8 offset:5120
    ds_read_b128 v[152:155], v8 offset:6144
    ds_read_b128 v[156:159], v8 offset:7168
    s_waitcnt lgkmcnt(7)
    buffer_store_dwordx4 v[128:131], v9, s[32:35], s53 offen sc1
    s_add_u32 s53, s53, 28672
    s_waitcnt lgkmcnt(6)
    buffer_store_dwordx4 v[132:135], v9, s[32:35], s53 offen sc1
    s_add_u32 s53, s53, 28672
    s_waitcnt lgkmcnt(5)
    buffer_store_dwordx4 v[136:139], v9, s[32:35], s53 offen sc1
    s_add_u32 s53, s53, 28672
    s_waitcnt lgkmcnt(4)
    buffer_store_dwordx4 v[140:143], v9, s[32:35], s53 offen sc1
    s_add_u32 s53, s53, 28672
    s_waitcnt lgkmcnt(3)
    buffer_store_dwordx4 v[144:147], v9, s[32:35], s53 offen sc1
    s_add_u32 s53, s53, 28672
    s_waitcnt lgkmcnt(2)
    buffer_store_dwordx4 v[148:151], v9, s[32:35], s53 offen sc1
    s_add_u32 s53, s53, 28672
    s_waitcnt lgkmcnt(1)
    buffer_store_dwordx4 v[152:155], v9, s[32:35], s53 offen sc1
    s_add_u32 s53, s53, 28672
    s_waitcnt lgkmcnt(0)
    buffer_store_dwordx4 v[156:159], v9, s[32:35], s53 offen sc1
    s_cmp_eq_u32 s46, 1
    s_cbranch_scc1 P_JOIN
    s_mov_b32 s62, 0
UPL_10:
    buffer_load_dword v245, v244, s[32:35], s45 offen sc1
UPLCK_12:
    s_waitcnt vmcnt(0)
    v_cmp_ne_u32 vcc, 0, v245
    s_add_u32 s62, s62, 1
    s_cmp_eq_u64 vcc, -1
    s_cbranch_scc1 UPLOK_11
    s_cmp_ge_u32 s62, 32768
    s_cbranch_scc1 UPLOK_11
    s_sleep 4
    s_branch UPL_10

UPLOK_11:
    v_lshlrev_b32 v2, 4, v1
    s_add_u32 s43, s40, s41
    s_add_u32 m0, s43, 512
    s_add_u32 s44, s38, s41
    s_add_u32 s44, s44, 8388608
    buffer_load_dwordx4 v2, s[32:35], s44 offen lds
    s_add_u32 m0, s43, 1536
    s_add_u32 s44, s44, 1024
    buffer_load_dwordx4 v2, s[32:35], s44 offen lds

    s_waitcnt vmcnt(0)
    s_branch P_JOIN
P_NOG1:
    s_cmp_lg_u32 s2, 255
    s_cbranch_scc1 NZ_13
    v_lshlrev_b32 v2, 4, v0
    v_mov_b32 v8, 0
    v_mov_b32 v9, 0
    v_mov_b32 v10, 0
    v_mov_b32 v11, 0
    s_mov_b32 s53, 13631488

    buffer_store_dwordx4 v[8:11], v2, s[32:35], s53 offen sc1
    s_add_u32 s53, s53, 4096
    buffer_store_dwordx4 v[8:11], v2, s[32:35], s53 offen sc1
    s_add_u32 s53, s53, 4096
    buffer_store_dwordx4 v[8:11], v2, s[32:35], s53 offen sc1
    s_add_u32 s53, s53, 4096
    buffer_store_dwordx4 v[8:11], v2, s[32:35], s53 offen sc1
    s_add_u32 s53, s53, 4096
    buffer_store_dwordx4 v[8:11], v2, s[32:35], s53 offen sc1
    s_add_u32 s53, s53, 4096
    buffer_store_dwordx4 v[8:11], v2, s[32:35], s53 offen sc1
    s_add_u32 s53, s53, 4096
    buffer_store_dwordx4 v[8:11], v2, s[32:35], s53 offen sc1
    s_add_u32 s53, s53, 4096
    buffer_store_dwordx4 v[8:11], v2, s[32:35], s53 offen sc1
    s_waitcnt vmcnt(0)
    s_barrier
    v_lshlrev_b32 v2, 7, v1
    v_mov_b32 v3, 1
    v_cmp_gt_u32 vcc, 2, v0
    s_and_saveexec_b64 s[62:63], vcc
    s_cbranch_execz NZ_13_X
    buffer_store_dword v3, v2, s[20:23], 0 offen sc1

NZ_13_X:
    s_mov_b64 exec, s[62:63]
NZ_13:
    v_lshrrev_b32 v2, 5, v1
    v_and_b32 v6, 31, v1
    s_lshl_b32 s36, s59, 6
    s_lshl_b32 s38, s3, 4
    s_add_u32 s36, s36, s38
    v_lshlrev_b32 v2, 3, v2
    v_add_u32 v3, s36, v2
    s_lshl_b32 s37, s58, 6
    v_lshlrev_b32 v6, 1, v6
    v_add_u32 v6, s37, v6
    v_lshlrev_b32 v4, 10, v3
    v_lshl_add_u32 v4, v6, 1, v4
    v_subrev_u32 v5, 3072, v4
    v_cmp_eq_u32 vcc, 0, v3
    v_mov_b32 v7, 0x80000000
    s_nop 1
    v_cndmask_b32 v5, v5, v7, vcc
    s_movk_i32 s39, 0x1000
    buffer_load_dword v16, v5, s[8:11], 0 offen
    buffer_load_dword v17, v5, s[8:11], 0 offen offset:1024
    buffer_load_dword v18, v5, s[8:11], 0 offen offset:2048

    buffer_load_dword v19, v4, s[8:11], 0 offen offset:0
    buffer_load_dword v20, v4, s[8:11], 0 offen offset:1024
    buffer_load_dword v21, v4, s[8:11], 0 offen offset:2048
    buffer_load_dword v22, v4, s[8:11], 0 offen offset:3072
    buffer_load_dword v23, v4, s[8:11], s39 offen offset:0
    buffer_load_dword v24, v4, s[8:11], s39 offen offset:1024
    buffer_load_dword v25, v4, s[8:11], s39 offen offset:2048
    buffer_load_dword v26, v4, s[8:11], s39 offen offset:3072
    buffer_load_dword v27, v4, s[12:15], 0 offen offset:0
    buffer_load_dword v28, v4, s[12:15], 0 offen offset:1024
    buffer_load_dword v29, v4, s[12:15], 0 offen offset:2048
    buffer_load_dword v30, v4, s[12:15], 0 offen offset:3072
    buffer_load_dword v31, v4, s[12:15], s39 offen offset:0
    buffer_load_dword v32, v4, s[12:15], s39 offen offset:1024
    buffer_load_dword v33, v4, s[12:15], s39 offen offset:2048
    buffer_load_dword v34, v4, s[12:15], s39 offen offset:3072
    v_lshlrev_b32 v8, 3, v6
    buffer_load_dwordx4 v[36:39], v8, s[16:19], 0 offen
    v_mov_b32 v124, v3
    v_mov_b32 v125, v6

    s_mov_b32 s48, s80
    s_and_b32 s49, s81, 0xffff
    s_mov_b32 s50, 1835008
    s_mov_b32 s51, 0x00020000
    v_lshrrev_b32 v2, 3, v1
    s_lshl_b32 s53, s3, 3
    v_add_u32 v2, s53, v2
    v_lshrrev_b32 v3, 4, v1
    v_and_b32 v5, 7, v1
    v_and_b32 v4, 1, v3
    v_lshlrev_b32 v4, 2, v4
    v_xor_b32 v6, v5, v4
    v_lshlrev_b32 v7, 10, v2
    v_lshl_add_u32 v200, v6, 4, v7
    s_sub_u32 s56, s59, 28
    s_mul_i32 s57, s56, 458752
    s_lshl_b32 s60, s58, 7
    s_add_u32 s57, s57, s60
    s_lshl_b32 s52, s3, 10

    s_add_u32 m0, s52, 0
    s_add_u32 s60, s57, 0
    buffer_load_dwordx4 v200, s[48:51], s60 offen lds
    s_add_u32 m0, s52, 4096
    s_add_u32 s60, s57, 32768
    buffer_load_dwordx4 v200, s[48:51], s60 offen lds
    s_add_u32 m0, s52, 8192
    s_add_u32 s60, s57, 65536
    buffer_load_dwordx4 v200, s[48:51], s60 offen lds
    s_add_u32 m0, s52, 12288
    s_add_u32 s60, s57, 98304
    buffer_load_dwordx4 v200, s[48:51], s60 offen lds
    s_add_u32 m0, s52, 16384
    s_add_u32 s60, s57, 131072
    buffer_load_dwordx4 v200, s[48:51], s60 offen lds
    s_add_u32 m0, s52, 20480
    s_add_u32 s60, s57, 163840
    buffer_load_dwordx4 v200, s[48:51], s60 offen lds
    s_add_u32 m0, s52, 24576
    s_add_u32 s60, s57, 196608
    buffer_load_dwordx4 v200, s[48:51], s60 offen lds
    s_add_u32 m0, s52, 28672
    s_add_u32 s60, s57, 229376
    buffer_load_dwordx4 v200, s[48:51], s60 offen lds
    s_add_u32 m0, s52, 32768
    s_add_u32 s60, s57, 262144
    buffer_load_dwordx4 v200, s[48:51], s60 offen lds
    s_add_u32 m0, s52, 36864
    s_add_u32 s60, s57, 294912
    buffer_load_dwordx4 v200, s[48:51], s60 offen lds
    s_add_u32 m0, s52, 40960
    s_add_u32 s60, s57, 327680
    buffer_load_dwordx4 v200, s[48:51], s60 offen lds
    s_add_u32 m0, s52, 45056
    s_add_u32 s60, s57, 360448
    buffer_load_dwordx4 v200, s[48:51], s60 offen lds
    s_add_u32 m0, s52, 49152
    s_add_u32 s60, s57, 393216
    buffer_load_dwordx4 v200, s[48:51], s60 offen lds
    s_add_u32 m0, s52, 53248
    s_add_u32 s60, s57, 425984
    buffer_load_dwordx4 v200, s[48:51], s60 offen lds
    s_waitcnt vmcnt(14)
    v_mov_b32 v3, v124
    v_mov_b32 v6, v125
    v_lshlrev_b32 v52, 16, v16
    v_and_b32 v53, 0xffff0000, v16
    v_lshlrev_b32 v54, 16, v17
    v_and_b32 v55, 0xffff0000, v17
    v_lshlrev_b32 v56, 16, v18
    v_and_b32 v57, 0xffff0000, v18
    v_lshlrev_b32 v58, 16, v19
    v_and_b32 v59, 0xffff0000, v19
    v_lshlrev_b32 v60, 16, v20
    v_and_b32 v61, 0xffff0000, v20
    v_lshlrev_b32 v62, 16, v21
    v_and_b32 v63, 0xffff0000, v21
    v_lshlrev_b32 v64, 16, v22
    v_and_b32 v65, 0xffff0000, v22
    v_lshlrev_b32 v66, 16, v23
    v_and_b32 v67, 0xffff0000, v23
    v_lshlrev_b32 v68, 16, v24
    v_and_b32 v69, 0xffff0000, v24
    v_lshlrev_b32 v70, 16, v25
    v_and_b32 v71, 0xffff0000, v25
    v_lshlrev_b32 v72, 16, v26
    v_and_b32 v73, 0xffff0000, v26
    v_lshlrev_b32 v74, 16, v27
    v_and_b32 v75, 0xffff0000, v27
    v_lshlrev_b32 v76, 16, v28
    v_and_b32 v77, 0xffff0000, v28
    v_lshlrev_b32 v78, 16, v29
    v_and_b32 v79, 0xffff0000, v29
    v_lshlrev_b32 v80, 16, v30
    v_and_b32 v81, 0xffff0000, v30
    v_lshlrev_b32 v82, 16, v31
    v_and_b32 v83, 0xffff0000, v31
    v_lshlrev_b32 v84, 16, v32
    v_and_b32 v85, 0xffff0000, v32
    v_lshlrev_b32 v86, 16, v33
    v_and_b32 v87, 0xffff0000, v33
    v_lshlrev_b32 v88, 16, v34
    v_and_b32 v89, 0xffff0000, v34
    v_lshlrev_b32 v90, 16, v36
    v_lshlrev_b32 v91, 16, v38
    v_and_b32 v92, 0xffff0000, v36
    v_and_b32 v93, 0xffff0000, v38
    v_lshlrev_b32 v94, 16, v37
    v_lshlrev_b32 v95, 16, v39
    v_and_b32 v96, 0xffff0000, v37
    v_and_b32 v97, 0xffff0000, v39
    v_pk_mul_f32 v[98:99], v[52:53], v[96:97]
    v_pk_fma_f32 v[98:99], v[54:55], v[94:95], v[98:99]
    v_pk_fma_f32 v[98:99], v[56:57], v[92:93], v[98:99]
    v_pk_fma_f32 v[98:99], v[58:59], v[90:91], v[98:99]
    v_pk_mul_f32 v[100:101], v[54:55], v[96:97]
    v_pk_fma_f32 v[100:101], v[56:57], v[94:95], v[100:101]
    v_pk_fma_f32 v[100:101], v[58:59], v[92:93], v[100:101]
    v_pk_fma_f32 v[100:101], v[60:61], v[90:91], v[100:101]
    v_pk_mul_f32 v[102:103], v[56:57], v[96:97]
    v_pk_fma_f32 v[102:103], v[58:59], v[94:95], v[102:103]
    v_pk_fma_f32 v[102:103], v[60:61], v[92:93], v[102:103]
    v_pk_fma_f32 v[102:103], v[62:63], v[90:91], v[102:103]
    v_pk_mul_f32 v[104:105], v[58:59], v[96:97]
    v_pk_fma_f32 v[104:105], v[60:61], v[94:95], v[104:105]
    v_pk_fma_f32 v[104:105], v[62:63], v[92:93], v[104:105]
    v_pk_fma_f32 v[104:105], v[64:65], v[90:91], v[104:105]
    v_pk_mul_f32 v[106:107], v[60:61], v[96:97]
    v_pk_fma_f32 v[106:107], v[62:63], v[94:95], v[106:107]
    v_pk_fma_f32 v[106:107], v[64:65], v[92:93], v[106:107]
    v_pk_fma_f32 v[106:107], v[66:67], v[90:91], v[106:107]
    v_pk_mul_f32 v[108:109], v[62:63], v[96:97]
    v_pk_fma_f32 v[108:109], v[64:65], v[94:95], v[108:109]
    v_pk_fma_f32 v[108:109], v[66:67], v[92:93], v[108:109]
    v_pk_fma_f32 v[108:109], v[68:69], v[90:91], v[108:109]
    v_pk_mul_f32 v[110:111], v[64:65], v[96:97]
    v_pk_fma_f32 v[110:111], v[66:67], v[94:95], v[110:111]
    v_pk_fma_f32 v[110:111], v[68:69], v[92:93], v[110:111]
    v_pk_fma_f32 v[110:111], v[70:71], v[90:91], v[110:111]
    v_pk_mul_f32 v[112:113], v[66:67], v[96:97]
    v_pk_fma_f32 v[112:113], v[68:69], v[94:95], v[112:113]
    v_pk_fma_f32 v[112:113], v[70:71], v[92:93], v[112:113]
    v_pk_fma_f32 v[112:113], v[72:73], v[90:91], v[112:113]
    v_cvt_pk_bf16_f32 v2, v98, v99
    v_lshlrev_b32 v98, 16, v2
    v_and_b32 v99, 0xffff0000, v2
    v_pk_mul_f32 v[98:99], v[98:99], v[74:75]
    v_cvt_pk_bf16_f32 v2, v100, v101
    v_lshlrev_b32 v100, 16, v2
    v_and_b32 v101, 0xffff0000, v2
    v_pk_mul_f32 v[100:101], v[100:101], v[76:77]
    v_cvt_pk_bf16_f32 v2, v102, v103
    v_lshlrev_b32 v102, 16, v2
    v_and_b32 v103, 0xffff0000, v2
    v_pk_mul_f32 v[102:103], v[102:103], v[78:79]
    v_cvt_pk_bf16_f32 v2, v104, v105
    v_lshlrev_b32 v104, 16, v2
    v_and_b32 v105, 0xffff0000, v2
    v_pk_mul_f32 v[104:105], v[104:105], v[80:81]
    v_cvt_pk_bf16_f32 v2, v106, v107
    v_lshlrev_b32 v106, 16, v2
    v_and_b32 v107, 0xffff0000, v2
    v_pk_mul_f32 v[106:107], v[106:107], v[82:83]
    v_cvt_pk_bf16_f32 v2, v108, v109
    v_lshlrev_b32 v108, 16, v2
    v_and_b32 v109, 0xffff0000, v2
    v_pk_mul_f32 v[108:109], v[108:109], v[84:85]
    v_cvt_pk_bf16_f32 v2, v110, v111
    v_lshlrev_b32 v110, 16, v2
    v_and_b32 v111, 0xffff0000, v2
    v_pk_mul_f32 v[110:111], v[110:111], v[86:87]
    v_cvt_pk_bf16_f32 v2, v112, v113
    v_lshlrev_b32 v112, 16, v2
    v_and_b32 v113, 0xffff0000, v2
    v_pk_mul_f32 v[112:113], v[112:113], v[88:89]
    v_cvt_pk_bf16_f32 v116, v98, v100
    v_cvt_pk_bf16_f32 v120, v99, v101
    v_cvt_pk_bf16_f32 v117, v102, v104
    v_cvt_pk_bf16_f32 v121, v103, v105
    v_cvt_pk_bf16_f32 v118, v106, v108
    v_cvt_pk_bf16_f32 v122, v107, v109
    v_cvt_pk_bf16_f32 v119, v110, v112
    v_cvt_pk_bf16_f32 v123, v111, v113
    v_lshlrev_b32 v2, 12, v6
    v_lshl_add_u32 v2, v3, 1, v2
    s_mov_b32 s43, 8388608
    s_mov_b32 s44, 8392704
    buffer_store_dwordx4 v[116:119], v2, s[32:35], s43 offen sc1
    buffer_store_dwordx4 v[120:123], v2, s[32:35], s44 offen sc1

    s_waitcnt vmcnt(2)
    s_barrier
    v_lshrrev_b32 v3, 5, v1
    v_bfe_u32 v4, v1, 2, 2
    v_and_b32 v5, 3, v1
    v_bfe_u32 v6, v1, 4, 1
    v_lshl_add_u32 v7, v3, 3, v4
    s_lshl_b32 s53, s3, 4
    v_add_u32 v7, s53, v7
    v_lshlrev_b32 v7, 7, v7
    v_and_b32 v8, 1, v5
    v_lshl_add_u32 v7, v8, 3, v7
    v_lshrrev_b32 v8, 1, v5
    v_lshl_add_u32 v8, v6, 1, v8
    v_lshrrev_b32 v9, 1, v4
    v_lshlrev_b32 v9, 2, v9
    v_xor_b32 v10, v8, v9
    v_lshl_add_u32 v201, v10, 4, v7
    v_xor_b32 v10, 4, v10
    v_lshl_add_u32 v202, v10, 4, v7

    s_mul_i32 s57, s58, 28
    s_mul_i32 s60, s56, 7
    s_add_u32 s57, s57, s60
    s_lshl_b32 s57, s57, 13
    s_lshl_b32 s60, s3, 11
    s_add_u32 s57, s57, s60
    s_add_u32 s57, s57, 14745600
    v_lshlrev_b32 v203, 4, v1

    ds_read_b64_tr_b16 v[128:129], v201 offset:0
    ds_read_b64_tr_b16 v[130:131], v201 offset:512
    ds_read_b64_tr_b16 v[132:133], v202 offset:0
    ds_read_b64_tr_b16 v[134:135], v202 offset:512
    ds_read_b64_tr_b16 v[136:137], v201 offset:8192
    ds_read_b64_tr_b16 v[138:139], v201 offset:8704
    ds_read_b64_tr_b16 v[140:141], v202 offset:8192
    ds_read_b64_tr_b16 v[142:143], v202 offset:8704
    ds_read_b64_tr_b16 v[144:145], v201 offset:16384
    ds_read_b64_tr_b16 v[146:147], v201 offset:16896
    ds_read_b64_tr_b16 v[148:149], v202 offset:16384
    ds_read_b64_tr_b16 v[150:151], v202 offset:16896
    ds_read_b64_tr_b16 v[152:153], v201 offset:24576
    ds_read_b64_tr_b16 v[154:155], v201 offset:25088
    ds_read_b64_tr_b16 v[156:157], v202 offset:24576
    ds_read_b64_tr_b16 v[158:159], v202 offset:25088
    ds_read_b64_tr_b16 v[160:161], v201 offset:32768
    ds_read_b64_tr_b16 v[162:163], v201 offset:33280
    ds_read_b64_tr_b16 v[164:165], v202 offset:32768
    ds_read_b64_tr_b16 v[166:167], v202 offset:33280
    ds_read_b64_tr_b16 v[168:169], v201 offset:40960
    ds_read_b64_tr_b16 v[170:171], v201 offset:41472
    ds_read_b64_tr_b16 v[172:173], v202 offset:40960
    ds_read_b64_tr_b16 v[174:175], v202 offset:41472
    ds_read_b64_tr_b16 v[176:177], v201 offset:49152
    ds_read_b64_tr_b16 v[178:179], v201 offset:49664
    ds_read_b64_tr_b16 v[180:181], v202 offset:49152
    ds_read_b64_tr_b16 v[182:183], v202 offset:49664
    s_waitcnt lgkmcnt(15)
    s_add_u32 s60, s57, 0
    buffer_store_dwordx4 v[128:131], v203, s[32:35], s60 offen sc1
    s_add_u32 s60, s57, 1024
    buffer_store_dwordx4 v[132:135], v203, s[32:35], s60 offen sc1
    s_waitcnt lgkmcnt(15)
    s_add_u32 s60, s57, 8192
    buffer_store_dwordx4 v[136:139], v203, s[32:35], s60 offen sc1
    s_add_u32 s60, s57, 9216
    buffer_store_dwordx4 v[140:143], v203, s[32:35], s60 offen sc1
    s_waitcnt lgkmcnt(15)
    s_add_u32 s60, s57, 16384
    buffer_store_dwordx4 v[144:147], v203, s[32:35], s60 offen sc1
    s_add_u32 s60, s57, 17408
    buffer_store_dwordx4 v[148:151], v203, s[32:35], s60 offen sc1
    s_waitcnt lgkmcnt(12)
    s_add_u32 s60, s57, 24576
    buffer_store_dwordx4 v[152:155], v203, s[32:35], s60 offen sc1
    s_add_u32 s60, s57, 25600
    buffer_store_dwordx4 v[156:159], v203, s[32:35], s60 offen sc1
    s_waitcnt lgkmcnt(8)
    s_add_u32 s60, s57, 32768
    buffer_store_dwordx4 v[160:163], v203, s[32:35], s60 offen sc1
    s_add_u32 s60, s57, 33792
    buffer_store_dwordx4 v[164:167], v203, s[32:35], s60 offen sc1
    s_waitcnt lgkmcnt(4)
    s_add_u32 s60, s57, 40960
    buffer_store_dwordx4 v[168:171], v203, s[32:35], s60 offen sc1
    s_add_u32 s60, s57, 41984
    buffer_store_dwordx4 v[172:175], v203, s[32:35], s60 offen sc1
    s_waitcnt lgkmcnt(0)
    s_add_u32 s60, s57, 49152
    buffer_store_dwordx4 v[176:179], v203, s[32:35], s60 offen sc1
    s_add_u32 s60, s57, 50176
    buffer_store_dwordx4 v[180:183], v203, s[32:35], s60 offen sc1
    s_cmp_lg_u32 s3, 0
    s_cbranch_scc1 W0_14
    s_and_b32 s53, s2, 1
    s_lshl_b32 s53, s53, 7
    v_mov_b32 v246, s53
    buffer_load_dword v247, v246, s[20:23], 0 offen sc1

W0_14:
    s_mov_b32 s8, s80
    s_and_b32 s9, s81, 0xffff
    s_mov_b32 s10, 1835008
    s_mov_b32 s11, 0x00020000
    s_mov_b32 s12, s84
    s_and_b32 s13, s85, 0xffff
    s_mov_b32 s14, 2097152
    s_mov_b32 s15, 0x00020000
    s_mov_b32 s16, s72
    s_and_b32 s17, s73, 0xffff
    s_mov_b32 s18, 2097152
    s_mov_b32 s19, 0x00020000
    s_mov_b32 s28, s74
    s_and_b32 s29, s75, 0xffff
    s_mov_b32 s30, 1024
    s_mov_b32 s31, 0x00020000
    s_lshr_b32 s36, s3, 1
    s_and_b32 s37, s3, 1
    s_lshl_b32 s42, s2, 1
    s_add_u32 s42, s42, s36
    s_lshl_b32 s38, s42, 12
    s_mul_i32 s39, s36, 16640
    s_add_u32 s39, s39, 32768
    s_mul_i32 s40, s36, 4608
    s_add_u32 s40, s40, 131072
    s_lshl_b32 s41, s37, 11

    v_lshlrev_b32 v2, 4, v1
    s_add_u32 s43, s38, s41
    v_add_u32 v3, s43, v2
    v_subrev_u32 v4, 4, v3
    v_subrev_u32 v5, 8, v3
    buffer_load_dwordx4 v[16:19], v3, s[16:19], 0 offen
    buffer_load_dwordx4 v[20:23], v4, s[16:19], 0 offen
    buffer_load_dwordx4 v[24:27], v5, s[16:19], 0 offen
    v_add_u32 v4, 1024, v4
    v_add_u32 v5, 1024, v5
    buffer_load_dwordx4 v[28:31], v3, s[16:19], 0 offen offset:1024
    buffer_load_dwordx4 v[32:35], v4, s[16:19], 0 offen
    buffer_load_dwordx4 v[36:39], v5, s[16:19], 0 offen
    s_lshl_b32 s43, s42, 1
    v_mov_b32 v6, s43
    buffer_load_ushort v40, v6, s[28:31], 0 offen

    s_and_b32 s47, s59, 7
    s_mul_i32 s47, s47, 229376
    s_lshl_b32 s53, s3, 13
    s_add_u32 s47, s47, s53
    s_add_u32 s47, s47, 14745600
    v_lshlrev_b32 v252, 4, v1

    s_waitcnt vmcnt(0)
    s_barrier
    s_cmp_lg_u32 s3, 0
    s_cbranch_scc1 W0_15
    s_mov_b32 s62, 0
    s_waitcnt vmcnt(0)
    s_branch FZCK_18
FZ_16:
    buffer_load_dword v247, v246, s[20:23], 0 offen sc1
    s_waitcnt vmcnt(0)
FZCK_18:
    v_cmp_ne_u32 vcc, 0, v247
    s_add_u32 s62, s62, 1
    s_cmp_eq_u64 vcc, -1
    s_cbranch_scc1 FZOK_17
    s_cmp_ge_u32 s62, 32768
    s_cbranch_scc1 FZOK_17
    s_sleep 4
    s_branch FZ_16

FZOK_17:
    s_lshl_b32 s53, s58, 10
    s_lshl_b32 s54, s59, 2
    s_add_u32 s53, s53, s54
    s_add_u32 s53, s53, 13631488

    v_lshlrev_b32 v246, 7, v1
    v_mov_b32 v247, 1
    v_cmp_gt_u32 vcc, 8, v1
    s_and_saveexec_b64 s[62:63], vcc
    buffer_store_dword v247, v246, s[32:35], s53 offen sc1
    s_mov_b64 exec, s[62:63]

W0_15:
    s_cmp_lg_u32 s3, 0
    s_cbranch_scc1 W0_19
    s_lshl_b32 s53, s58, 10
    s_lshl_b32 s54, s56, 2
    s_add_u32 s53, s53, s54
    s_add_u32 s53, s53, 13656064

    v_lshlrev_b32 v246, 7, v1
    v_mov_b32 v247, 1
    v_cmp_gt_u32 vcc, 8, v1
    s_and_saveexec_b64 s[62:63], vcc
    buffer_store_dword v247, v246, s[32:35], s53 offen sc1
    s_mov_b64 exec, s[62:63]

W0_19:
    s_barrier
    s_and_b32 s77, s59, 7
    s_lshl_b32 s77, s77, 3
    s_add_u32 s77, s77, s58
    s_lshl_b32 s77, s77, 7
    s_add_u32 s77, s77, 13656064
    v_and_b32 v248, 3, v1
    v_lshlrev_b32 v248, 2, v248

    s_mov_b32 s62, 0
WP2_20:
    buffer_load_dword v249, v248, s[32:35], s77 offen sc1
WP2CK_22:
    s_waitcnt vmcnt(0)
    v_cmp_ne_u32 vcc, 0, v249
    s_add_u32 s62, s62, 1
    s_cmp_eq_u64 vcc, -1
    s_cbranch_scc1 WP2OK_21
    s_cmp_ge_u32 s62, 32768
    s_cbranch_scc1 WP2OK_21
    s_sleep 4
    s_branch WP2_20

WP2OK_21:
    s_add_u32 s54, s47, 0
    buffer_load_dwordx4 a[0:3], v252, s[32:35], s54 offen
    s_add_u32 s54, s47, 1024
    buffer_load_dwordx4 a[4:7], v252, s[32:35], s54 offen
    s_add_u32 s54, s47, 2048
    buffer_load_dwordx4 a[8:11], v252, s[32:35], s54 offen
    s_add_u32 s54, s47, 3072
    buffer_load_dwordx4 a[12:15], v252, s[32:35], s54 offen
    s_add_u32 s54, s47, 4096
    buffer_load_dwordx4 a[16:19], v252, s[32:35], s54 offen
    s_add_u32 s54, s47, 5120
    buffer_load_dwordx4 a[20:23], v252, s[32:35], s54 offen
    s_add_u32 s54, s47, 6144
    buffer_load_dwordx4 a[24:27], v252, s[32:35], s54 offen
    s_add_u32 s54, s47, 7168
    buffer_load_dwordx4 a[28:31], v252, s[32:35], s54 offen
    s_add_u32 s54, s47, 32768
    buffer_load_dwordx4 a[32:35], v252, s[32:35], s54 offen
    s_add_u32 s54, s47, 33792
    buffer_load_dwordx4 a[36:39], v252, s[32:35], s54 offen
    s_add_u32 s54, s47, 34816
    buffer_load_dwordx4 a[40:43], v252, s[32:35], s54 offen
    s_add_u32 s54, s47, 35840
    buffer_load_dwordx4 a[44:47], v252, s[32:35], s54 offen
    s_add_u32 s54, s47, 36864
    buffer_load_dwordx4 a[48:51], v252, s[32:35], s54 offen
    s_add_u32 s54, s47, 37888
    buffer_load_dwordx4 a[52:55], v252, s[32:35], s54 offen
    s_add_u32 s54, s47, 38912
    buffer_load_dwordx4 a[56:59], v252, s[32:35], s54 offen
    s_add_u32 s54, s47, 39936
    buffer_load_dwordx4 a[60:63], v252, s[32:35], s54 offen
    s_add_u32 s54, s47, 65536
    buffer_load_dwordx4 a[64:67], v252, s[32:35], s54 offen
    s_add_u32 s54, s47, 66560
    buffer_load_dwordx4 a[68:71], v252, s[32:35], s54 offen
    s_add_u32 s54, s47, 67584
    buffer_load_dwordx4 a[72:75], v252, s[32:35], s54 offen
    s_add_u32 s54, s47, 68608
    buffer_load_dwordx4 a[76:79], v252, s[32:35], s54 offen
    s_add_u32 s54, s47, 69632
    buffer_load_dwordx4 a[80:83], v252, s[32:35], s54 offen
    s_add_u32 s54, s47, 70656
    buffer_load_dwordx4 a[84:87], v252, s[32:35], s54 offen
    s_add_u32 s54, s47, 71680
    buffer_load_dwordx4 a[88:91], v252, s[32:35], s54 offen
    s_add_u32 s54, s47, 72704
    buffer_load_dwordx4 a[92:95], v252, s[32:35], s54 offen
    s_add_u32 s54, s47, 98304
    buffer_load_dwordx4 a[96:99], v252, s[32:35], s54 offen
    s_add_u32 s54, s47, 99328
    buffer_load_dwordx4 a[100:103], v252, s[32:35], s54 offen
    s_cmp_lg_u32 s3, 0
    s_cbranch_scc1 W0_23
    s_lshr_b32 s45, s2, 5
    s_lshl_b32 s45, s45, 3
    s_add_u32 s45, s45, s58
    s_lshl_b32 s45, s45, 7
    s_add_u32 s45, s45, 13631488
    v_and_b32 v244, 31, v1
    v_lshlrev_b32 v244, 2, v244

    s_mov_b32 s62, 0
UP2_24:
    buffer_load_dword v245, v244, s[32:35], s45 offen sc1
UP2CK_26:
    s_waitcnt vmcnt(0)
    v_cmp_ne_u32 vcc, 0, v245
    s_add_u32 s62, s62, 1
    s_cmp_eq_u64 vcc, -1
    s_cbranch_scc1 UP2OK_25
    s_cmp_ge_u32 s62, 32768
    s_cbranch_scc1 UP2OK_25
    s_sleep 4
    s_branch UP2_24

UP2OK_25:
W0_23:
    s_barrier
    v_lshlrev_b32 v2, 4, v1
    s_add_u32 s43, s40, s41
    s_add_u32 m0, s43, 512
    s_add_u32 s44, s38, s41
    s_add_u32 s44, s44, 8388608
    buffer_load_dwordx4 v2, s[32:35], s44 offen lds
    s_add_u32 m0, s43, 1536
    s_add_u32 s44, s44, 1024
    buffer_load_dwordx4 v2, s[32:35], s44 offen lds

    s_mov_b32 s76, 0
    s_waitcnt vmcnt(0)
P_JOIN:
    s_waitcnt vmcnt(38)
    v_lshlrev_b32 v2, 4, v1
    v_mov_b32 v44, 0
    v_mov_b32 v45, 0
    v_mov_b32 v46, 0
    v_mov_b32 v47, 0
    v_add_u32 v7, s40, v2
    v_subrev_u32 v8, 32, v1
    v_lshrrev_b32 v9, 2, v8
    v_mul_u32_u24 v9, 4160, v9
    v_and_b32 v8, 3, v8
    v_lshl_add_u32 v9, v8, 4, v9
    v_add_u32 v9, s39, v9
    v_cmp_gt_u32 vcc, 32, v1
    s_nop 1
    v_cndmask_b32 v7, v9, v7, vcc
    v_cmp_gt_u32 vcc, 48, v1
    s_and_saveexec_b64 s[62:63], vcc
    ds_write_b128 v7, v[44:47]
    s_mov_b64 exec, s[62:63]
    v_lshrrev_b32 v12, 4, v1
    v_bfe_u32 v13, v1, 2, 2
    v_and_b32 v14, 3, v1
    v_lshrrev_b32 v15, 1, v12
    v_and_b32 v41, 1, v12
    v_lshlrev_b32 v42, 5, v15
    v_lshlrev_b32 v43, 4, v41
    v_mul_u32_u24 v10, 4160, v13
    v_add_u32 v10, v10, v42
    v_sub_u32 v10, v10, v43
    v_lshl_add_u32 v10, v14, 3, v10
    s_lshl_b32 s43, s37, 8
    s_add_u32 s44, s39, s43
    s_add_u32 s44, s44, 56
    v_add_u32 v10, s44, v10
    v_and_b32 v11, 15, v1
    v_lshlrev_b32 v11, 5, v11
    v_sub_u32 v11, v11, v42
    v_add_u32 v11, v11, v43
    s_sub_u32 s44, s40, s43
    s_add_u32 s44, s44, 320
    v_add_u32 v11, s44, v11
    s_add_u32 s44, s39, s41
    s_add_u32 s44, s44, 64
    v_add_u32 v9, s44, v2
    v_or_b32 v8, s37, v1
    v_cmp_eq_u32 vcc, 0, v8
    s_nop 1
    v_cndmask_b32 v20, v20, v44, vcc
    v_cndmask_b32 v24, v24, v44, vcc
    v_cndmask_b32 v25, v25, v44, vcc

    v_alignbit_b32 v48, v16, v20, 16
    v_alignbit_b32 v52, v20, v24, 16
    v_alignbit_b32 v49, v17, v21, 16
    v_alignbit_b32 v53, v21, v25, 16
    v_alignbit_b32 v50, v18, v22, 16
    v_alignbit_b32 v54, v22, v26, 16
    v_alignbit_b32 v51, v19, v23, 16
    v_alignbit_b32 v55, v23, v27, 16
    ds_write_b128 v9, v[16:19] offset:0
    ds_write_b128 v9, v[48:51] offset:4160
    ds_write_b128 v9, v[20:23] offset:8320
    ds_write_b128 v9, v[52:55] offset:12480
    s_nop 2
    v_alignbit_b32 v48, v28, v32, 16
    v_alignbit_b32 v52, v32, v36, 16
    v_alignbit_b32 v49, v29, v33, 16
    v_alignbit_b32 v53, v33, v37, 16
    v_alignbit_b32 v50, v30, v34, 16
    v_alignbit_b32 v54, v34, v38, 16
    v_alignbit_b32 v51, v31, v35, 16
    v_alignbit_b32 v55, v35, v39, 16
    ds_write_b128 v9, v[28:31] offset:1024
    ds_write_b128 v9, v[48:51] offset:5184
    ds_write_b128 v9, v[32:35] offset:9344
    ds_write_b128 v9, v[52:55] offset:13504
    s_lshr_b32 s60, s59, 3
    s_lshl_b32 s61, s58, 2
    s_add_u32 s60, s60, s61
    s_and_b32 s61, s59, 7
    s_lshl_b32 s55, s60, 6
    s_lshl_b32 s56, s61, 7
    s_mul_i32 s48, s55, 3584
    s_lshl_b32 s53, s3, 7
    s_add_u32 s48, s48, s53
    s_lshl_b32 s50, s3, 15
    s_lshr_b32 s49, s3, 1
    v_lshrrev_b32 v2, 3, v1
    v_lshrrev_b32 v3, 4, v1
    v_and_b32 v5, 7, v1
    v_xor_b32 v6, v5, v3
    v_mul_u32_u24 v7, 3584, v2
    v_lshl_add_u32 v238, v6, 4, v7
    v_xor_b32 v239, 64, v238

    s_waitcnt vmcnt(16) lgkmcnt(0)
    s_barrier
    ds_read_b64_tr_b16 v[64:65], v10 offset:8
    ds_read_b64_tr_b16 v[66:67], v10 offset:0
    ds_read_b128 v[96:99], v11 offset:192
    ds_read_b64_tr_b16 v[68:69], v10 offset:520
    ds_read_b64_tr_b16 v[70:71], v10 offset:512
    ds_read_b128 v[100:103], v11 offset:704
    ds_read_b64_tr_b16 v[72:73], v10 offset:1032
    ds_read_b64_tr_b16 v[74:75], v10 offset:1024
    ds_read_b128 v[104:107], v11 offset:1216
    ds_read_b64_tr_b16 v[76:77], v10 offset:1544
    ds_read_b64_tr_b16 v[78:79], v10 offset:1536
    ds_read_b128 v[108:111], v11 offset:1728
    ds_read_b64_tr_b16 v[80:81], v10 offset:2056
    ds_read_b64_tr_b16 v[82:83], v10 offset:2048
    ds_read_b128 v[112:115], v11 offset:2240
    ds_read_b64_tr_b16 v[84:85], v10 offset:2568
    ds_read_b64_tr_b16 v[86:87], v10 offset:2560
    ds_read_b128 v[116:119], v11 offset:2752
    ds_read_b64_tr_b16 v[88:89], v10 offset:3080
    ds_read_b64_tr_b16 v[90:91], v10 offset:3072
    ds_read_b128 v[120:123], v11 offset:3264
    ds_read_b64_tr_b16 v[92:93], v10 offset:3592
    ds_read_b64_tr_b16 v[94:95], v10 offset:3584
    ds_read_b128 v[124:127], v11 offset:3776
    s_waitcnt lgkmcnt(0)
    v_mfma_f32_16x16x32_bf16 v[192:195], v[64:67], v[96:99], 0
    v_mfma_f32_16x16x32_bf16 v[196:199], v[64:67], v[100:103], 0
    s_add_u32 s54, s47, 100352
    buffer_load_dwordx4 a[104:107], v252, s[32:35], s54 offen
    v_mfma_f32_16x16x32_bf16 v[196:199], v[68:71], v[96:99], v[196:199]
    ds_read_b64_tr_b16 v[128:129], v10 offset:72
    ds_read_b64_tr_b16 v[130:131], v10 offset:64
    v_mfma_f32_16x16x32_bf16 v[200:203], v[64:67], v[104:107], 0
    v_mfma_f32_16x16x32_bf16 v[200:203], v[68:71], v[100:103], v[200:203]
    v_mfma_f32_16x16x32_bf16 v[200:203], v[72:75], v[96:99], v[200:203]
    ds_read_b128 v[160:163], v11 offset:128
    ds_read_b64_tr_b16 v[132:133], v10 offset:584
    v_mfma_f32_16x16x32_bf16 v[204:207], v[64:67], v[108:111], 0
    s_add_u32 s54, s47, 101376
    buffer_load_dwordx4 a[108:111], v252, s[32:35], s54 offen
    v_mfma_f32_16x16x32_bf16 v[204:207], v[68:71], v[104:107], v[204:207]
    v_mfma_f32_16x16x32_bf16 v[204:207], v[72:75], v[100:103], v[204:207]
    ds_read_b64_tr_b16 v[134:135], v10 offset:576
    ds_read_b128 v[164:167], v11 offset:640
    v_mfma_f32_16x16x32_bf16 v[204:207], v[76:79], v[96:99], v[204:207]
    v_mfma_f32_16x16x32_bf16 v[208:211], v[64:67], v[112:115], 0
    v_mfma_f32_16x16x32_bf16 v[208:211], v[68:71], v[108:111], v[208:211]
    ds_read_b64_tr_b16 v[136:137], v10 offset:1096
    ds_read_b64_tr_b16 v[138:139], v10 offset:1088
    s_add_u32 s54, s47, 102400
    buffer_load_dwordx4 a[112:115], v252, s[32:35], s54 offen
    v_mfma_f32_16x16x32_bf16 v[208:211], v[72:75], v[104:107], v[208:211]
    v_mfma_f32_16x16x32_bf16 v[208:211], v[76:79], v[100:103], v[208:211]
    v_mfma_f32_16x16x32_bf16 v[208:211], v[80:83], v[96:99], v[208:211]
    ds_read_b128 v[168:171], v11 offset:1152
    ds_read_b64_tr_b16 v[140:141], v10 offset:1608
    v_mfma_f32_16x16x32_bf16 v[212:215], v[64:67], v[116:119], 0
    v_mfma_f32_16x16x32_bf16 v[212:215], v[68:71], v[112:115], v[212:215]
    s_add_u32 s54, s47, 103424
    buffer_load_dwordx4 a[116:119], v252, s[32:35], s54 offen
    v_mfma_f32_16x16x32_bf16 v[212:215], v[72:75], v[108:111], v[212:215]
    ds_read_b64_tr_b16 v[142:143], v10 offset:1600
    ds_read_b128 v[172:175], v11 offset:1664
    v_mfma_f32_16x16x32_bf16 v[212:215], v[76:79], v[104:107], v[212:215]
    v_mfma_f32_16x16x32_bf16 v[212:215], v[80:83], v[100:103], v[212:215]
    v_mfma_f32_16x16x32_bf16 v[212:215], v[84:87], v[96:99], v[212:215]
    ds_read_b64_tr_b16 v[144:145], v10 offset:2120
    ds_read_b64_tr_b16 v[146:147], v10 offset:2112
    v_mfma_f32_16x16x32_bf16 v[216:219], v[64:67], v[120:123], 0
    s_add_u32 s54, s47, 104448
    buffer_load_dwordx4 a[120:123], v252, s[32:35], s54 offen
    v_mfma_f32_16x16x32_bf16 v[216:219], v[68:71], v[116:119], v[216:219]
    v_mfma_f32_16x16x32_bf16 v[216:219], v[72:75], v[112:115], v[216:219]
    ds_read_b128 v[176:179], v11 offset:2176
    ds_read_b64_tr_b16 v[148:149], v10 offset:2632
    v_mfma_f32_16x16x32_bf16 v[216:219], v[76:79], v[108:111], v[216:219]
    v_mfma_f32_16x16x32_bf16 v[216:219], v[80:83], v[104:107], v[216:219]
    v_mfma_f32_16x16x32_bf16 v[216:219], v[84:87], v[100:103], v[216:219]
    ds_read_b64_tr_b16 v[150:151], v10 offset:2624
    ds_read_b128 v[180:183], v11 offset:2688
    s_add_u32 s54, s47, 105472
    buffer_load_dwordx4 a[124:127], v252, s[32:35], s54 offen
    v_mfma_f32_16x16x32_bf16 v[216:219], v[88:91], v[96:99], v[216:219]
    v_mfma_f32_16x16x32_bf16 v[220:223], v[64:67], v[124:127], 0
    v_mfma_f32_16x16x32_bf16 v[220:223], v[68:71], v[120:123], v[220:223]
    ds_read_b64_tr_b16 v[152:153], v10 offset:3144
    ds_read_b64_tr_b16 v[154:155], v10 offset:3136
    v_mfma_f32_16x16x32_bf16 v[220:223], v[72:75], v[116:119], v[220:223]
    v_mfma_f32_16x16x32_bf16 v[220:223], v[76:79], v[112:115], v[220:223]
    s_add_u32 s54, s47, 131072
    buffer_load_dwordx4 a[128:131], v252, s[32:35], s54 offen
    v_mfma_f32_16x16x32_bf16 v[220:223], v[80:83], v[108:111], v[220:223]
    ds_read_b128 v[184:187], v11 offset:3200
    ds_read_b64_tr_b16 v[156:157], v10 offset:3656
    v_mfma_f32_16x16x32_bf16 v[220:223], v[84:87], v[104:107], v[220:223]
    v_mfma_f32_16x16x32_bf16 v[220:223], v[88:91], v[100:103], v[220:223]
    v_mfma_f32_16x16x32_bf16 v[220:223], v[92:95], v[96:99], v[220:223]
    ds_read_b64_tr_b16 v[158:159], v10 offset:3648
    ds_read_b128 v[188:191], v11 offset:3712
    s_waitcnt vmcnt(7)
    s_barrier
    s_cmp_lg_u32 s3, 0
    s_cbranch_scc1 W0_27
    s_cmp_eq_u32 s76, 0
    s_cbranch_scc1 NHF_28
    v_lshlrev_b32 v246, 7, v1
    v_mov_b32 v247, 1
    v_cmp_gt_u32 vcc, 4, v1
    s_and_saveexec_b64 s[62:63], vcc
    buffer_store_dword v247, v246, s[32:35], s76 offen sc1
    s_mov_b64 exec, s[62:63]

NHF_28:
W0_27:
    s_waitcnt lgkmcnt(0)
    v_mfma_f32_16x16x32_bf16 v[192:195], v[128:131], v[160:163], v[192:195]
    v_mfma_f32_16x16x32_bf16 v[196:199], v[128:131], v[164:167], v[196:199]
    s_add_u32 s54, s47, 132096
    buffer_load_dwordx4 a[132:135], v252, s[32:35], s54 offen
    v_mfma_f32_16x16x32_bf16 v[196:199], v[132:135], v[160:163], v[196:199]
    ds_read_b64_tr_b16 v[64:65], v10 offset:136
    ds_read_b64_tr_b16 v[66:67], v10 offset:128
    v_mfma_f32_16x16x32_bf16 v[200:203], v[128:131], v[168:171], v[200:203]
    v_mfma_f32_16x16x32_bf16 v[200:203], v[132:135], v[164:167], v[200:203]
    v_mfma_f32_16x16x32_bf16 v[200:203], v[136:139], v[160:163], v[200:203]
    ds_read_b128 v[96:99], v11 offset:64
    ds_read_b64_tr_b16 v[68:69], v10 offset:648
    v_mfma_f32_16x16x32_bf16 v[204:207], v[128:131], v[172:175], v[204:207]
    s_add_u32 s54, s47, 133120
    buffer_load_dwordx4 a[136:139], v252, s[32:35], s54 offen
    v_mfma_f32_16x16x32_bf16 v[204:207], v[132:135], v[168:171], v[204:207]
    v_mfma_f32_16x16x32_bf16 v[204:207], v[136:139], v[164:167], v[204:207]
    ds_read_b64_tr_b16 v[70:71], v10 offset:640
    ds_read_b128 v[100:103], v11 offset:576
    v_mfma_f32_16x16x32_bf16 v[204:207], v[140:143], v[160:163], v[204:207]
    v_mfma_f32_16x16x32_bf16 v[208:211], v[128:131], v[176:179], v[208:211]
    v_mfma_f32_16x16x32_bf16 v[208:211], v[132:135], v[172:175], v[208:211]
    ds_read_b64_tr_b16 v[72:73], v10 offset:1160
    ds_read_b64_tr_b16 v[74:75], v10 offset:1152
    s_add_u32 s54, s47, 134144
    buffer_load_dwordx4 a[140:143], v252, s[32:35], s54 offen
    v_mfma_f32_16x16x32_bf16 v[208:211], v[136:139], v[168:171], v[208:211]
    v_mfma_f32_16x16x32_bf16 v[208:211], v[140:143], v[164:167], v[208:211]
    v_mfma_f32_16x16x32_bf16 v[208:211], v[144:147], v[160:163], v[208:211]
    ds_read_b128 v[104:107], v11 offset:1088
    ds_read_b64_tr_b16 v[76:77], v10 offset:1672
    v_mfma_f32_16x16x32_bf16 v[212:215], v[128:131], v[180:183], v[212:215]
    v_mfma_f32_16x16x32_bf16 v[212:215], v[132:135], v[176:179], v[212:215]
    s_add_u32 s54, s47, 135168
    buffer_load_dwordx4 a[144:147], v252, s[32:35], s54 offen
    v_mfma_f32_16x16x32_bf16 v[212:215], v[136:139], v[172:175], v[212:215]
    ds_read_b64_tr_b16 v[78:79], v10 offset:1664
    ds_read_b128 v[108:111], v11 offset:1600
    v_mfma_f32_16x16x32_bf16 v[212:215], v[140:143], v[168:171], v[212:215]
    v_mfma_f32_16x16x32_bf16 v[212:215], v[144:147], v[164:167], v[212:215]
    v_mfma_f32_16x16x32_bf16 v[212:215], v[148:151], v[160:163], v[212:215]
    ds_read_b64_tr_b16 v[80:81], v10 offset:2184
    ds_read_b64_tr_b16 v[82:83], v10 offset:2176
    v_mfma_f32_16x16x32_bf16 v[216:219], v[128:131], v[184:187], v[216:219]
    s_add_u32 s54, s47, 136192
    buffer_load_dwordx4 a[148:151], v252, s[32:35], s54 offen
    v_mfma_f32_16x16x32_bf16 v[216:219], v[132:135], v[180:183], v[216:219]
    v_mfma_f32_16x16x32_bf16 v[216:219], v[136:139], v[176:179], v[216:219]
    ds_read_b128 v[112:115], v11 offset:2112
    ds_read_b64_tr_b16 v[84:85], v10 offset:2696
    v_mfma_f32_16x16x32_bf16 v[216:219], v[140:143], v[172:175], v[216:219]
    v_mfma_f32_16x16x32_bf16 v[216:219], v[144:147], v[168:171], v[216:219]
    v_mfma_f32_16x16x32_bf16 v[216:219], v[148:151], v[164:167], v[216:219]
    ds_read_b64_tr_b16 v[86:87], v10 offset:2688
    ds_read_b128 v[116:119], v11 offset:2624
    s_add_u32 s54, s47, 137216
    buffer_load_dwordx4 a[152:155], v252, s[32:35], s54 offen
    v_mfma_f32_16x16x32_bf16 v[216:219], v[152:155], v[160:163], v[216:219]
    v_mfma_f32_16x16x32_bf16 v[220:223], v[128:131], v[188:191], v[220:223]
    v_mfma_f32_16x16x32_bf16 v[220:223], v[132:135], v[184:187], v[220:223]
    ds_read_b64_tr_b16 v[88:89], v10 offset:3208
    ds_read_b64_tr_b16 v[90:91], v10 offset:3200
    v_mfma_f32_16x16x32_bf16 v[220:223], v[136:139], v[180:183], v[220:223]
    v_mfma_f32_16x16x32_bf16 v[220:223], v[140:143], v[176:179], v[220:223]
    s_add_u32 s54, s47, 138240
    buffer_load_dwordx4 a[156:159], v252, s[32:35], s54 offen
    v_mfma_f32_16x16x32_bf16 v[220:223], v[144:147], v[172:175], v[220:223]
    ds_read_b128 v[120:123], v11 offset:3136
    ds_read_b64_tr_b16 v[92:93], v10 offset:3720
    v_mfma_f32_16x16x32_bf16 v[220:223], v[148:151], v[168:171], v[220:223]
    v_mfma_f32_16x16x32_bf16 v[220:223], v[152:155], v[164:167], v[220:223]
    v_mfma_f32_16x16x32_bf16 v[220:223], v[156:159], v[160:163], v[220:223]
    ds_read_b64_tr_b16 v[94:95], v10 offset:3712
    ds_read_b128 v[124:127], v11 offset:3648
    s_waitcnt lgkmcnt(0)
    v_mfma_f32_16x16x32_bf16 v[192:195], v[64:67], v[96:99], v[192:195]
    v_mfma_f32_16x16x32_bf16 v[196:199], v[64:67], v[100:103], v[196:199]
    s_add_u32 s54, s47, 163840
    buffer_load_dwordx4 a[160:163], v252, s[32:35], s54 offen
    v_mfma_f32_16x16x32_bf16 v[196:199], v[68:71], v[96:99], v[196:199]
    ds_read_b64_tr_b16 v[128:129], v10 offset:200
    ds_read_b64_tr_b16 v[130:131], v10 offset:192
    v_mfma_f32_16x16x32_bf16 v[200:203], v[64:67], v[104:107], v[200:203]
    v_mfma_f32_16x16x32_bf16 v[200:203], v[68:71], v[100:103], v[200:203]
    v_mfma_f32_16x16x32_bf16 v[200:203], v[72:75], v[96:99], v[200:203]
    ds_read_b128 v[160:163], v11 offset:0
    ds_read_b64_tr_b16 v[132:133], v10 offset:712
    v_mfma_f32_16x16x32_bf16 v[204:207], v[64:67], v[108:111], v[204:207]
    s_add_u32 s54, s47, 164864
    buffer_load_dwordx4 a[164:167], v252, s[32:35], s54 offen
    v_mfma_f32_16x16x32_bf16 v[204:207], v[68:71], v[104:107], v[204:207]
    v_mfma_f32_16x16x32_bf16 v[204:207], v[72:75], v[100:103], v[204:207]
    ds_read_b64_tr_b16 v[134:135], v10 offset:704
    ds_read_b128 v[164:167], v11 offset:512
    v_mfma_f32_16x16x32_bf16 v[204:207], v[76:79], v[96:99], v[204:207]
    v_mfma_f32_16x16x32_bf16 v[208:211], v[64:67], v[112:115], v[208:211]
    v_mfma_f32_16x16x32_bf16 v[208:211], v[68:71], v[108:111], v[208:211]
    ds_read_b64_tr_b16 v[136:137], v10 offset:1224
    ds_read_b64_tr_b16 v[138:139], v10 offset:1216
    s_add_u32 s54, s47, 165888
    buffer_load_dwordx4 a[168:171], v252, s[32:35], s54 offen
    v_mfma_f32_16x16x32_bf16 v[208:211], v[72:75], v[104:107], v[208:211]
    v_mfma_f32_16x16x32_bf16 v[208:211], v[76:79], v[100:103], v[208:211]
    v_mfma_f32_16x16x32_bf16 v[208:211], v[80:83], v[96:99], v[208:211]
    ds_read_b128 v[168:171], v11 offset:1024
    ds_read_b64_tr_b16 v[140:141], v10 offset:1736
    v_mfma_f32_16x16x32_bf16 v[212:215], v[64:67], v[116:119], v[212:215]
    v_mfma_f32_16x16x32_bf16 v[212:215], v[68:71], v[112:115], v[212:215]
    s_add_u32 s54, s47, 166912
    buffer_load_dwordx4 a[172:175], v252, s[32:35], s54 offen
    v_mfma_f32_16x16x32_bf16 v[212:215], v[72:75], v[108:111], v[212:215]
    ds_read_b64_tr_b16 v[142:143], v10 offset:1728
    ds_read_b128 v[172:175], v11 offset:1536
    v_mfma_f32_16x16x32_bf16 v[212:215], v[76:79], v[104:107], v[212:215]
    v_mfma_f32_16x16x32_bf16 v[212:215], v[80:83], v[100:103], v[212:215]
    v_mfma_f32_16x16x32_bf16 v[212:215], v[84:87], v[96:99], v[212:215]
    ds_read_b64_tr_b16 v[144:145], v10 offset:2248
    ds_read_b64_tr_b16 v[146:147], v10 offset:2240
    v_mfma_f32_16x16x32_bf16 v[216:219], v[64:67], v[120:123], v[216:219]
    s_add_u32 s54, s47, 167936
    buffer_load_dwordx4 a[176:179], v252, s[32:35], s54 offen
    v_mfma_f32_16x16x32_bf16 v[216:219], v[68:71], v[116:119], v[216:219]
    v_mfma_f32_16x16x32_bf16 v[216:219], v[72:75], v[112:115], v[216:219]
    ds_read_b128 v[176:179], v11 offset:2048
    ds_read_b64_tr_b16 v[148:149], v10 offset:2760
    v_mfma_f32_16x16x32_bf16 v[216:219], v[76:79], v[108:111], v[216:219]
    v_mfma_f32_16x16x32_bf16 v[216:219], v[80:83], v[104:107], v[216:219]
    v_mfma_f32_16x16x32_bf16 v[216:219], v[84:87], v[100:103], v[216:219]
    ds_read_b64_tr_b16 v[150:151], v10 offset:2752
    ds_read_b128 v[180:183], v11 offset:2560
    s_add_u32 s54, s47, 168960
    buffer_load_dwordx4 a[180:183], v252, s[32:35], s54 offen
    v_mfma_f32_16x16x32_bf16 v[216:219], v[88:91], v[96:99], v[216:219]
    v_mfma_f32_16x16x32_bf16 v[220:223], v[64:67], v[124:127], v[220:223]
    v_mfma_f32_16x16x32_bf16 v[220:223], v[68:71], v[120:123], v[220:223]
    ds_read_b64_tr_b16 v[152:153], v10 offset:3272
    ds_read_b64_tr_b16 v[154:155], v10 offset:3264
    v_mfma_f32_16x16x32_bf16 v[220:223], v[72:75], v[116:119], v[220:223]
    v_mfma_f32_16x16x32_bf16 v[220:223], v[76:79], v[112:115], v[220:223]
    s_add_u32 s54, s47, 169984
    buffer_load_dwordx4 a[184:187], v252, s[32:35], s54 offen
    v_mfma_f32_16x16x32_bf16 v[220:223], v[80:83], v[108:111], v[220:223]
    ds_read_b128 v[184:187], v11 offset:3072
    ds_read_b64_tr_b16 v[156:157], v10 offset:3784
    v_mfma_f32_16x16x32_bf16 v[220:223], v[84:87], v[104:107], v[220:223]
    v_mfma_f32_16x16x32_bf16 v[220:223], v[88:91], v[100:103], v[220:223]
    v_mfma_f32_16x16x32_bf16 v[220:223], v[92:95], v[96:99], v[220:223]
    ds_read_b64_tr_b16 v[158:159], v10 offset:3776
    ds_read_b128 v[188:191], v11 offset:3584
    s_cmp_lg_u32 s3, 0
    s_cbranch_scc1 W0_29
    s_lshr_b32 s46, s60, 1
    s_lshl_b32 s46, s46, 2
    s_and_b32 s53, s61, 3
    s_add_u32 s46, s46, s53
    s_lshl_b32 s46, s46, 7
    s_add_u32 s46, s46, 13639680
    v_min_u32 v244, 13, v1
    v_lshlrev_b32 v244, 2, v244
    buffer_load_dword v245, v244, s[32:35], s46 offen sc1

W0_29:
    s_waitcnt lgkmcnt(0)
    v_mfma_f32_16x16x32_bf16 v[192:195], v[128:131], v[160:163], v[192:195]
    v_mfma_f32_16x16x32_bf16 v[196:199], v[128:131], v[164:167], v[196:199]
    s_add_u32 s54, s47, 171008
    buffer_load_dwordx4 a[188:191], v252, s[32:35], s54 offen
    v_mfma_f32_16x16x32_bf16 v[196:199], v[132:135], v[160:163], v[196:199]
    v_mfma_f32_16x16x32_bf16 v[200:203], v[128:131], v[168:171], v[200:203]
    v_mfma_f32_16x16x32_bf16 v[200:203], v[132:135], v[164:167], v[200:203]
    v_mfma_f32_16x16x32_bf16 v[200:203], v[136:139], v[160:163], v[200:203]
    v_mfma_f32_16x16x32_bf16 v[204:207], v[128:131], v[172:175], v[204:207]
    s_add_u32 s54, s47, 196608
    buffer_load_dwordx4 a[192:195], v252, s[32:35], s54 offen
    v_mfma_f32_16x16x32_bf16 v[204:207], v[132:135], v[168:171], v[204:207]
    v_mfma_f32_16x16x32_bf16 v[204:207], v[136:139], v[164:167], v[204:207]
    v_mfma_f32_16x16x32_bf16 v[204:207], v[140:143], v[160:163], v[204:207]
    v_mfma_f32_16x16x32_bf16 v[208:211], v[128:131], v[176:179], v[208:211]
    v_mfma_f32_16x16x32_bf16 v[208:211], v[132:135], v[172:175], v[208:211]
    s_add_u32 s54, s47, 197632
    buffer_load_dwordx4 a[196:199], v252, s[32:35], s54 offen
    v_mfma_f32_16x16x32_bf16 v[208:211], v[136:139], v[168:171], v[208:211]
    v_mfma_f32_16x16x32_bf16 v[208:211], v[140:143], v[164:167], v[208:211]
    v_mfma_f32_16x16x32_bf16 v[208:211], v[144:147], v[160:163], v[208:211]
    v_mfma_f32_16x16x32_bf16 v[212:215], v[128:131], v[180:183], v[212:215]
    v_mfma_f32_16x16x32_bf16 v[212:215], v[132:135], v[176:179], v[212:215]
    s_add_u32 s54, s47, 198656
    buffer_load_dwordx4 a[200:203], v252, s[32:35], s54 offen
    v_mfma_f32_16x16x32_bf16 v[212:215], v[136:139], v[172:175], v[212:215]
    v_mfma_f32_16x16x32_bf16 v[212:215], v[140:143], v[168:171], v[212:215]
    v_mfma_f32_16x16x32_bf16 v[212:215], v[144:147], v[164:167], v[212:215]
    v_mfma_f32_16x16x32_bf16 v[212:215], v[148:151], v[160:163], v[212:215]
    v_mfma_f32_16x16x32_bf16 v[216:219], v[128:131], v[184:187], v[216:219]
    s_add_u32 s54, s47, 199680
    buffer_load_dwordx4 a[204:207], v252, s[32:35], s54 offen
    v_mfma_f32_16x16x32_bf16 v[216:219], v[132:135], v[180:183], v[216:219]
    v_mfma_f32_16x16x32_bf16 v[216:219], v[136:139], v[176:179], v[216:219]
    v_mfma_f32_16x16x32_bf16 v[216:219], v[140:143], v[172:175], v[216:219]
    v_mfma_f32_16x16x32_bf16 v[216:219], v[144:147], v[168:171], v[216:219]
    v_mfma_f32_16x16x32_bf16 v[216:219], v[148:151], v[164:167], v[216:219]
    s_add_u32 s54, s47, 200704
    buffer_load_dwordx4 a[208:211], v252, s[32:35], s54 offen
    v_mfma_f32_16x16x32_bf16 v[216:219], v[152:155], v[160:163], v[216:219]
    v_mfma_f32_16x16x32_bf16 v[220:223], v[128:131], v[188:191], v[220:223]
    v_mfma_f32_16x16x32_bf16 v[220:223], v[132:135], v[184:187], v[220:223]
    v_mfma_f32_16x16x32_bf16 v[220:223], v[136:139], v[180:183], v[220:223]
    v_mfma_f32_16x16x32_bf16 v[220:223], v[140:143], v[176:179], v[220:223]
    s_add_u32 s54, s47, 201728
    buffer_load_dwordx4 a[212:215], v252, s[32:35], s54 offen
    v_mfma_f32_16x16x32_bf16 v[220:223], v[144:147], v[172:175], v[220:223]
    v_mfma_f32_16x16x32_bf16 v[220:223], v[148:151], v[168:171], v[220:223]
    v_mfma_f32_16x16x32_bf16 v[220:223], v[152:155], v[164:167], v[220:223]
    v_mfma_f32_16x16x32_bf16 v[220:223], v[156:159], v[160:163], v[220:223]
    s_add_u32 s54, s47, 202752
    buffer_load_dwordx4 a[216:219], v252, s[32:35], s54 offen
    s_add_u32 s54, s47, 203776
    buffer_load_dwordx4 a[220:223], v252, s[32:35], s54 offen
    s_nop 15
    v_lshlrev_b32 v2, 4, v1
    s_lshl_b32 s43, s3, 12
    s_add_u32 s43, s43, 140288
    v_add_u32 v12, s43, v2
    s_xor_b32 s44, s3, 1
    s_lshl_b32 s44, s44, 12
    s_add_u32 s44, s44, 140288
    v_add_u32 v13, s44, v2
    s_cmp_eq_u32 s37, 0

    s_cbranch_scc0 CVH1_30
    ds_write_b128 v12, v[208:211] offset:0
    ds_write_b128 v12, v[212:215] offset:1024
    ds_write_b128 v12, v[216:219] offset:2048
    ds_write_b128 v12, v[220:223] offset:3072
    v_mov_b32 v64, v192
    v_mov_b32 v65, v193
    v_mov_b32 v66, v194
    v_mov_b32 v67, v195
    v_mov_b32 v68, v196
    v_mov_b32 v69, v197
    v_mov_b32 v70, v198
    v_mov_b32 v71, v199
    v_mov_b32 v72, v200
    v_mov_b32 v73, v201
    v_mov_b32 v74, v202
    v_mov_b32 v75, v203
    v_mov_b32 v76, v204
    v_mov_b32 v77, v205
    v_mov_b32 v78, v206
    v_mov_b32 v79, v207
    s_branch CVJ_31
CVH1_30:
    ds_write_b128 v12, v[192:195] offset:0
    ds_write_b128 v12, v[196:199] offset:1024
    ds_write_b128 v12, v[200:203] offset:2048
    ds_write_b128 v12, v[204:207] offset:3072
    v_mov_b32 v64, v208
    v_mov_b32 v65, v209
    v_mov_b32 v66, v210
    v_mov_b32 v67, v211
    v_mov_b32 v68, v212
    v_mov_b32 v69, v213
    v_mov_b32 v70, v214
    v_mov_b32 v71, v215
    v_mov_b32 v72, v216
    v_mov_b32 v73, v217
    v_mov_b32 v74, v218
    v_mov_b32 v75, v219
    v_mov_b32 v76, v220
    v_mov_b32 v77, v221
    v_mov_b32 v78, v222
    v_mov_b32 v79, v223
CVJ_31:
    v_and_b32 v14, 15, v1
    v_lshlrev_b32 v14, 5, v14
    v_lshrrev_b32 v15, 4, v1
    v_lshl_add_u32 v14, v15, 3, v14
    s_lshl_b32 s43, s37, 11
    s_add_u32 s44, s40, s43
    s_add_u32 s44, s44, 512
    v_add_u32 v15, s44, v14
    s_add_u32 s45, s38, s43
    s_add_u32 s45, s45, 10485760

    s_cmp_lg_u32 s3, 0
    s_cbranch_scc1 W0_32
    s_mov_b32 s62, 0
    s_branch HPCK_35
HP_33:
    buffer_load_dword v245, v244, s[32:35], s46 offen sc1
HPCK_35:
    s_waitcnt vmcnt(0)
    v_cmp_ne_u32 vcc, 0, v245
    s_add_u32 s62, s62, 1
    s_cmp_eq_u64 vcc, -1
    s_cbranch_scc1 HPOK_34
    s_cmp_ge_u32 s62, 32768
    s_cbranch_scc1 HPOK_34
    s_sleep 4
    s_branch HP_33

HPOK_34:
W0_32:
    s_waitcnt lgkmcnt(0)
    s_barrier
    s_add_u32 m0, s50, 0
    s_add_u32 s54, s48, 0
    buffer_load_dwordx4 v238, s[32:35], s54 offen lds
    s_add_u32 m0, s50, 1024
    s_add_u32 s54, s48, 28672
    buffer_load_dwordx4 v239, s[32:35], s54 offen lds
    s_add_u32 m0, s50, 2048
    s_add_u32 s54, s48, 57344
    buffer_load_dwordx4 v238, s[32:35], s54 offen lds
    s_add_u32 m0, s50, 3072
    s_add_u32 s54, s48, 86016
    buffer_load_dwordx4 v239, s[32:35], s54 offen lds
    s_add_u32 m0, s50, 4096
    s_add_u32 s54, s48, 114688
    buffer_load_dwordx4 v238, s[32:35], s54 offen lds
    s_add_u32 m0, s50, 5120
    s_add_u32 s54, s48, 143360
    buffer_load_dwordx4 v239, s[32:35], s54 offen lds
    s_add_u32 m0, s50, 6144
    s_add_u32 s54, s48, 172032
    buffer_load_dwordx4 v238, s[32:35], s54 offen lds
    s_add_u32 m0, s50, 7168
    s_add_u32 s54, s48, 200704
    buffer_load_dwordx4 v239, s[32:35], s54 offen lds
    s_add_u32 m0, s50, 8192
    s_add_u32 s54, s48, 512
    buffer_load_dwordx4 v238, s[32:35], s54 offen lds
    s_add_u32 m0, s50, 9216
    s_add_u32 s54, s48, 29184
    buffer_load_dwordx4 v239, s[32:35], s54 offen lds
    s_add_u32 m0, s50, 10240
    s_add_u32 s54, s48, 57856
    buffer_load_dwordx4 v238, s[32:35], s54 offen lds
    s_add_u32 m0, s50, 11264
    s_add_u32 s54, s48, 86528
    buffer_load_dwordx4 v239, s[32:35], s54 offen lds
    ds_read_b128 v[80:83], v13 offset:0
    ds_read_b64 v[96:97], v15 offset:0
    ds_read_b128 v[84:87], v13 offset:1024
    ds_read_b64 v[98:99], v15 offset:512
    ds_read_b128 v[88:91], v13 offset:2048
    ds_read_b64 v[100:101], v15 offset:1024
    ds_read_b128 v[92:95], v13 offset:3072
    ds_read_b64 v[102:103], v15 offset:1536
    v_lshlrev_b32 v40, 16, v40
    s_add_u32 m0, s50, 12288
    s_add_u32 s54, s48, 115200
    buffer_load_dwordx4 v238, s[32:35], s54 offen lds
    s_add_u32 m0, s50, 13312
    s_add_u32 s54, s48, 143872
    buffer_load_dwordx4 v239, s[32:35], s54 offen lds
    s_add_u32 m0, s50, 14336
    s_add_u32 s54, s48, 172544
    buffer_load_dwordx4 v238, s[32:35], s54 offen lds
    s_add_u32 m0, s50, 15360
    s_add_u32 s54, s48, 201216
    buffer_load_dwordx4 v239, s[32:35], s54 offen lds
    s_waitcnt lgkmcnt(0)
    v_add_f32 v64, v64, v80
    v_add_f32 v65, v65, v81
    v_add_f32 v66, v66, v82
    v_add_f32 v67, v67, v83
    v_cvt_pk_bf16_f32 v104, v64, v65
    v_lshlrev_b32 v105, 16, v104
    v_and_b32 v106, 0xffff0000, v104
    v_lshlrev_b32 v107, 16, v96
    v_and_b32 v108, 0xffff0000, v96
    v_mul_f32 v107, v40, v107
    v_mul_f32 v108, v40, v108
    v_cvt_pk_bf16_f32 v104, v107, v108
    v_lshlrev_b32 v107, 16, v104
    v_and_b32 v108, 0xffff0000, v104
    v_add_f32 v105, v105, v107
    v_add_f32 v106, v106, v108
    v_cvt_pk_bf16_f32 v110, v105, v106
    v_cvt_pk_bf16_f32 v104, v66, v67
    v_lshlrev_b32 v105, 16, v104
    v_and_b32 v106, 0xffff0000, v104
    v_lshlrev_b32 v107, 16, v97
    v_and_b32 v108, 0xffff0000, v97
    v_mul_f32 v107, v40, v107
    v_mul_f32 v108, v40, v108
    v_cvt_pk_bf16_f32 v104, v107, v108
    v_lshlrev_b32 v107, 16, v104
    v_and_b32 v108, 0xffff0000, v104
    v_add_f32 v105, v105, v107
    v_add_f32 v106, v106, v108
    v_cvt_pk_bf16_f32 v111, v105, v106
    buffer_store_dwordx2 v[110:111], v14, s[32:35], s45 offen offset:0 sc1
    s_add_u32 m0, s50, 16384
    s_add_u32 s54, s48, 1024
    buffer_load_dwordx4 v238, s[32:35], s54 offen lds
    s_add_u32 m0, s50, 17408
    s_add_u32 s54, s48, 29696
    buffer_load_dwordx4 v239, s[32:35], s54 offen lds
    s_add_u32 m0, s50, 18432
    s_add_u32 s54, s48, 58368
    buffer_load_dwordx4 v238, s[32:35], s54 offen lds
    s_add_u32 m0, s50, 19456
    s_add_u32 s54, s48, 87040
    buffer_load_dwordx4 v239, s[32:35], s54 offen lds
    v_add_f32 v68, v68, v84
    v_add_f32 v69, v69, v85
    v_add_f32 v70, v70, v86
    v_add_f32 v71, v71, v87
    v_cvt_pk_bf16_f32 v104, v68, v69
    v_lshlrev_b32 v105, 16, v104
    v_and_b32 v106, 0xffff0000, v104
    v_lshlrev_b32 v107, 16, v98
    v_and_b32 v108, 0xffff0000, v98
    v_mul_f32 v107, v40, v107
    v_mul_f32 v108, v40, v108
    v_cvt_pk_bf16_f32 v104, v107, v108
    v_lshlrev_b32 v107, 16, v104
    v_and_b32 v108, 0xffff0000, v104
    v_add_f32 v105, v105, v107
    v_add_f32 v106, v106, v108
    v_cvt_pk_bf16_f32 v112, v105, v106
    v_cvt_pk_bf16_f32 v104, v70, v71
    v_lshlrev_b32 v105, 16, v104
    v_and_b32 v106, 0xffff0000, v104
    v_lshlrev_b32 v107, 16, v99
    v_and_b32 v108, 0xffff0000, v99
    v_mul_f32 v107, v40, v107
    v_mul_f32 v108, v40, v108
    v_cvt_pk_bf16_f32 v104, v107, v108
    v_lshlrev_b32 v107, 16, v104
    v_and_b32 v108, 0xffff0000, v104
    v_add_f32 v105, v105, v107
    v_add_f32 v106, v106, v108
    v_cvt_pk_bf16_f32 v113, v105, v106
    buffer_store_dwordx2 v[112:113], v14, s[32:35], s45 offen offset:512 sc1
    s_add_u32 m0, s50, 20480
    s_add_u32 s54, s48, 115712
    buffer_load_dwordx4 v238, s[32:35], s54 offen lds
    s_add_u32 m0, s50, 21504
    s_add_u32 s54, s48, 144384
    buffer_load_dwordx4 v239, s[32:35], s54 offen lds
    s_add_u32 m0, s50, 22528
    s_add_u32 s54, s48, 173056
    buffer_load_dwordx4 v238, s[32:35], s54 offen lds
    s_add_u32 m0, s50, 23552
    s_add_u32 s54, s48, 201728
    buffer_load_dwordx4 v239, s[32:35], s54 offen lds
    v_add_f32 v72, v72, v88
    v_add_f32 v73, v73, v89
    v_add_f32 v74, v74, v90
    v_add_f32 v75, v75, v91
    v_cvt_pk_bf16_f32 v104, v72, v73
    v_lshlrev_b32 v105, 16, v104
    v_and_b32 v106, 0xffff0000, v104
    v_lshlrev_b32 v107, 16, v100
    v_and_b32 v108, 0xffff0000, v100
    v_mul_f32 v107, v40, v107
    v_mul_f32 v108, v40, v108
    v_cvt_pk_bf16_f32 v104, v107, v108
    v_lshlrev_b32 v107, 16, v104
    v_and_b32 v108, 0xffff0000, v104
    v_add_f32 v105, v105, v107
    v_add_f32 v106, v106, v108
    v_cvt_pk_bf16_f32 v114, v105, v106
    v_cvt_pk_bf16_f32 v104, v74, v75
    v_lshlrev_b32 v105, 16, v104
    v_and_b32 v106, 0xffff0000, v104
    v_lshlrev_b32 v107, 16, v101
    v_and_b32 v108, 0xffff0000, v101
    v_mul_f32 v107, v40, v107
    v_mul_f32 v108, v40, v108
    v_cvt_pk_bf16_f32 v104, v107, v108
    v_lshlrev_b32 v107, 16, v104
    v_and_b32 v108, 0xffff0000, v104
    v_add_f32 v105, v105, v107
    v_add_f32 v106, v106, v108
    v_cvt_pk_bf16_f32 v115, v105, v106
    buffer_store_dwordx2 v[114:115], v14, s[32:35], s45 offen offset:1024 sc1
    s_add_u32 m0, s50, 24576
    s_add_u32 s54, s48, 1536
    buffer_load_dwordx4 v238, s[32:35], s54 offen lds
    s_add_u32 m0, s50, 25600
    s_add_u32 s54, s48, 30208
    buffer_load_dwordx4 v239, s[32:35], s54 offen lds
    s_add_u32 m0, s50, 26624
    s_add_u32 s54, s48, 58880
    buffer_load_dwordx4 v238, s[32:35], s54 offen lds
    s_add_u32 m0, s50, 27648
    s_add_u32 s54, s48, 87552
    buffer_load_dwordx4 v239, s[32:35], s54 offen lds
    v_add_f32 v76, v76, v92
    v_add_f32 v77, v77, v93
    v_add_f32 v78, v78, v94
    v_add_f32 v79, v79, v95
    v_cvt_pk_bf16_f32 v104, v76, v77
    v_lshlrev_b32 v105, 16, v104
    v_and_b32 v106, 0xffff0000, v104
    v_lshlrev_b32 v107, 16, v102
    v_and_b32 v108, 0xffff0000, v102
    v_mul_f32 v107, v40, v107
    v_mul_f32 v108, v40, v108
    v_cvt_pk_bf16_f32 v104, v107, v108
    v_lshlrev_b32 v107, 16, v104
    v_and_b32 v108, 0xffff0000, v104
    v_add_f32 v105, v105, v107
    v_add_f32 v106, v106, v108
    v_cvt_pk_bf16_f32 v116, v105, v106
    v_cvt_pk_bf16_f32 v104, v78, v79
    v_lshlrev_b32 v105, 16, v104
    v_and_b32 v106, 0xffff0000, v104
    v_lshlrev_b32 v107, 16, v103
    v_and_b32 v108, 0xffff0000, v103
    v_mul_f32 v107, v40, v107
    v_mul_f32 v108, v40, v108
    v_cvt_pk_bf16_f32 v104, v107, v108
    v_lshlrev_b32 v107, 16, v104
    v_and_b32 v108, 0xffff0000, v104
    v_add_f32 v105, v105, v107
    v_add_f32 v106, v106, v108
    v_cvt_pk_bf16_f32 v117, v105, v106
    buffer_store_dwordx2 v[116:117], v14, s[32:35], s45 offen offset:1536 sc1
    s_add_u32 m0, s50, 28672
    s_add_u32 s54, s48, 116224
    buffer_load_dwordx4 v238, s[32:35], s54 offen lds
    s_add_u32 m0, s50, 29696
    s_add_u32 s54, s48, 144896
    buffer_load_dwordx4 v239, s[32:35], s54 offen lds
    s_add_u32 m0, s50, 30720
    s_add_u32 s54, s48, 173568
    buffer_load_dwordx4 v238, s[32:35], s54 offen lds
    s_add_u32 m0, s50, 31744
    s_add_u32 s54, s48, 202240
    buffer_load_dwordx4 v239, s[32:35], s54 offen lds
    v_and_b32 v2, 31, v1
    v_lshlrev_b32 v2, 7, v2
    v_lshrrev_b32 v3, 5, v1
    v_bfe_u32 v5, v1, 1, 3
    v_xor_b32 v4, v3, v5
    v_lshl_add_u32 v2, v4, 4, v2
    v_add_u32 v192, s50, v2
    v_xor_b32 v193, 32, v192
    v_xor_b32 v194, 64, v192
    v_xor_b32 v195, 96, v192

    v_and_b32 v11, 15, v1
    s_lshl_b32 s53, s3, 4
    v_add_u32 v11, s53, v11
    v_add_u32 v12, s55, v11
    v_lshrrev_b32 v13, 4, v1
    v_lshlrev_b32 v14, 10, v12
    v_lshl_add_u32 v14, v13, 4, v14
    v_lshlrev_b32 v15, 2, v12
    s_mov_b32 s57, 12582912
    buffer_load_dwordx4 v[16:19], v14, s[4:7], s56 offen
    buffer_load_dwordx4 v[20:23], v14, s[4:7], s56 offen offset:64

    buffer_load_dword v24, v15, s[32:35], s57 offen sc1
    s_waitcnt vmcnt(39)
    s_waitcnt vmcnt(31)
    ds_read_b128 v[128:131], v192 offset:0
    ds_read_b128 v[132:135], v192 offset:4096
    ds_read_b128 v[136:139], v193 offset:0
    ds_read_b128 v[140:143], v193 offset:4096
    ds_read_b128 v[144:147], v194 offset:0
    ds_read_b128 v[148:151], v194 offset:4096
    s_waitcnt lgkmcnt(4)
    v_mfma_f32_32x32x16_bf16 v[64:79], a[0:3], v[128:131], 0
    v_mfma_f32_32x32x16_bf16 v[80:95], a[0:3], v[132:135], 0
    v_mfma_f32_32x32x16_bf16 v[96:111], a[4:7], v[128:131], 0
    v_mfma_f32_32x32x16_bf16 v[112:127], a[4:7], v[132:135], 0
    ds_read_b128 v[152:155], v195 offset:0
    ds_read_b128 v[156:159], v195 offset:4096
    s_waitcnt lgkmcnt(4)
    v_mfma_f32_32x32x16_bf16 v[64:79], a[8:11], v[136:139], v[64:79]
    v_mfma_f32_32x32x16_bf16 v[80:95], a[8:11], v[140:143], v[80:95]
    v_mfma_f32_32x32x16_bf16 v[96:111], a[12:15], v[136:139], v[96:111]
    v_mfma_f32_32x32x16_bf16 v[112:127], a[12:15], v[140:143], v[112:127]
    s_waitcnt vmcnt(23)
    ds_read_b128 v[128:131], v192 offset:8192
    ds_read_b128 v[132:135], v192 offset:12288
    s_waitcnt lgkmcnt(4)
    v_mfma_f32_32x32x16_bf16 v[64:79], a[16:19], v[144:147], v[64:79]
    v_mfma_f32_32x32x16_bf16 v[80:95], a[16:19], v[148:151], v[80:95]
    v_mfma_f32_32x32x16_bf16 v[96:111], a[20:23], v[144:147], v[96:111]
    v_mfma_f32_32x32x16_bf16 v[112:127], a[20:23], v[148:151], v[112:127]
    ds_read_b128 v[136:139], v193 offset:8192
    ds_read_b128 v[140:143], v193 offset:12288
    s_waitcnt lgkmcnt(4)
    v_mfma_f32_32x32x16_bf16 v[64:79], a[24:27], v[152:155], v[64:79]
    s_add_u32 m0, s50, 0
    s_add_u32 s54, s48, 2048
    buffer_load_dwordx4 v238, s[32:35], s54 offen lds
    v_mfma_f32_32x32x16_bf16 v[80:95], a[24:27], v[156:159], v[80:95]
    s_add_u32 m0, s50, 1024
    s_add_u32 s54, s48, 30720
    buffer_load_dwordx4 v239, s[32:35], s54 offen lds
    v_mfma_f32_32x32x16_bf16 v[96:111], a[28:31], v[152:155], v[96:111]
    s_add_u32 m0, s50, 2048
    s_add_u32 s54, s48, 59392
    buffer_load_dwordx4 v238, s[32:35], s54 offen lds
    v_mfma_f32_32x32x16_bf16 v[112:127], a[28:31], v[156:159], v[112:127]
    s_add_u32 m0, s50, 3072
    s_add_u32 s54, s48, 88064
    buffer_load_dwordx4 v239, s[32:35], s54 offen lds
    ds_read_b128 v[144:147], v194 offset:8192
    ds_read_b128 v[148:151], v194 offset:12288
    s_waitcnt lgkmcnt(4)
    v_mfma_f32_32x32x16_bf16 v[64:79], a[32:35], v[128:131], v[64:79]
    s_add_u32 m0, s50, 4096
    s_add_u32 s54, s48, 116736
    buffer_load_dwordx4 v238, s[32:35], s54 offen lds
    v_mfma_f32_32x32x16_bf16 v[80:95], a[32:35], v[132:135], v[80:95]
    s_add_u32 m0, s50, 5120
    s_add_u32 s54, s48, 145408
    buffer_load_dwordx4 v239, s[32:35], s54 offen lds
    v_mfma_f32_32x32x16_bf16 v[96:111], a[36:39], v[128:131], v[96:111]
    s_add_u32 m0, s50, 6144
    s_add_u32 s54, s48, 174080
    buffer_load_dwordx4 v238, s[32:35], s54 offen lds
    v_mfma_f32_32x32x16_bf16 v[112:127], a[36:39], v[132:135], v[112:127]
    s_add_u32 m0, s50, 7168
    s_add_u32 s54, s48, 202752
    buffer_load_dwordx4 v239, s[32:35], s54 offen lds
    ds_read_b128 v[152:155], v195 offset:8192
    ds_read_b128 v[156:159], v195 offset:12288
    s_waitcnt lgkmcnt(4)
    v_mfma_f32_32x32x16_bf16 v[64:79], a[40:43], v[136:139], v[64:79]
    v_mfma_f32_32x32x16_bf16 v[80:95], a[40:43], v[140:143], v[80:95]
    v_mfma_f32_32x32x16_bf16 v[96:111], a[44:47], v[136:139], v[96:111]
    v_mfma_f32_32x32x16_bf16 v[112:127], a[44:47], v[140:143], v[112:127]
    s_waitcnt vmcnt(21)
    ds_read_b128 v[128:131], v192 offset:16384
    ds_read_b128 v[132:135], v192 offset:20480
    s_waitcnt lgkmcnt(4)
    s_waitcnt vmcnt(15)
    s_barrier
    v_mfma_f32_32x32x16_bf16 v[64:79], a[48:51], v[144:147], v[64:79]
    v_mfma_f32_32x32x16_bf16 v[80:95], a[48:51], v[148:151], v[80:95]
    v_mfma_f32_32x32x16_bf16 v[96:111], a[52:55], v[144:147], v[96:111]
    v_mfma_f32_32x32x16_bf16 v[112:127], a[52:55], v[148:151], v[112:127]
    s_cmp_lg_u32 s3, 0
    s_cbranch_scc1 W0_36
    s_lshr_b32 s53, s2, 5
    s_lshl_b32 s53, s53, 10
    s_and_b32 s54, s2, 31
    s_lshl_b32 s54, s54, 2
    s_add_u32 s53, s53, s54
    s_add_u32 s53, s53, 13647872

    v_lshlrev_b32 v246, 7, v1
    v_mov_b32 v247, 1
    v_cmp_gt_u32 vcc, 8, v1
    s_and_saveexec_b64 s[62:63], vcc
    buffer_store_dword v247, v246, s[32:35], s53 offen sc1
    s_mov_b64 exec, s[62:63]

W0_36:
    ds_read_b128 v[136:139], v193 offset:16384
    ds_read_b128 v[140:143], v193 offset:20480
    s_waitcnt lgkmcnt(4)
    v_mfma_f32_32x32x16_bf16 v[64:79], a[56:59], v[152:155], v[64:79]
    s_add_u32 m0, s50, 8192
    s_add_u32 s54, s48, 2560
    buffer_load_dwordx4 v238, s[32:35], s54 offen lds
    v_mfma_f32_32x32x16_bf16 v[80:95], a[56:59], v[156:159], v[80:95]
    s_add_u32 m0, s50, 9216
    s_add_u32 s54, s48, 31232
    buffer_load_dwordx4 v239, s[32:35], s54 offen lds
    v_mfma_f32_32x32x16_bf16 v[96:111], a[60:63], v[152:155], v[96:111]
    s_add_u32 m0, s50, 10240
    s_add_u32 s54, s48, 59904
    buffer_load_dwordx4 v238, s[32:35], s54 offen lds
    v_mfma_f32_32x32x16_bf16 v[112:127], a[60:63], v[156:159], v[112:127]
    s_add_u32 m0, s50, 11264
    s_add_u32 s54, s48, 88576
    buffer_load_dwordx4 v239, s[32:35], s54 offen lds
    ds_read_b128 v[144:147], v194 offset:16384
    ds_read_b128 v[148:151], v194 offset:20480
    s_waitcnt lgkmcnt(4)
    v_mfma_f32_32x32x16_bf16 v[64:79], a[64:67], v[128:131], v[64:79]
    s_add_u32 m0, s50, 12288
    s_add_u32 s54, s48, 117248
    buffer_load_dwordx4 v238, s[32:35], s54 offen lds
    v_mfma_f32_32x32x16_bf16 v[80:95], a[64:67], v[132:135], v[80:95]
    s_add_u32 m0, s50, 13312
    s_add_u32 s54, s48, 145920
    buffer_load_dwordx4 v239, s[32:35], s54 offen lds
    v_mfma_f32_32x32x16_bf16 v[96:111], a[68:71], v[128:131], v[96:111]
    s_add_u32 m0, s50, 14336
    s_add_u32 s54, s48, 174592
    buffer_load_dwordx4 v238, s[32:35], s54 offen lds
    v_mfma_f32_32x32x16_bf16 v[112:127], a[68:71], v[132:135], v[112:127]
    s_add_u32 m0, s50, 15360
    s_add_u32 s54, s48, 203264
    buffer_load_dwordx4 v239, s[32:35], s54 offen lds
    ds_read_b128 v[152:155], v195 offset:16384
    ds_read_b128 v[156:159], v195 offset:20480
    s_waitcnt lgkmcnt(4)
    v_mfma_f32_32x32x16_bf16 v[64:79], a[72:75], v[136:139], v[64:79]
    v_mfma_f32_32x32x16_bf16 v[80:95], a[72:75], v[140:143], v[80:95]
    v_mfma_f32_32x32x16_bf16 v[96:111], a[76:79], v[136:139], v[96:111]
    v_mfma_f32_32x32x16_bf16 v[112:127], a[76:79], v[140:143], v[112:127]
    s_waitcnt vmcnt(19)
    ds_read_b128 v[128:131], v192 offset:24576
    ds_read_b128 v[132:135], v192 offset:28672
    s_waitcnt lgkmcnt(4)
    v_mfma_f32_32x32x16_bf16 v[64:79], a[80:83], v[144:147], v[64:79]
    v_mfma_f32_32x32x16_bf16 v[80:95], a[80:83], v[148:151], v[80:95]
    v_mfma_f32_32x32x16_bf16 v[96:111], a[84:87], v[144:147], v[96:111]
    v_mfma_f32_32x32x16_bf16 v[112:127], a[84:87], v[148:151], v[112:127]
    ds_read_b128 v[136:139], v193 offset:24576
    ds_read_b128 v[140:143], v193 offset:28672
    s_waitcnt lgkmcnt(4)
    v_mfma_f32_32x32x16_bf16 v[64:79], a[88:91], v[152:155], v[64:79]
    s_add_u32 m0, s50, 16384
    s_add_u32 s54, s48, 3072
    buffer_load_dwordx4 v238, s[32:35], s54 offen lds
    v_mfma_f32_32x32x16_bf16 v[80:95], a[88:91], v[156:159], v[80:95]
    s_add_u32 m0, s50, 17408
    s_add_u32 s54, s48, 31744
    buffer_load_dwordx4 v239, s[32:35], s54 offen lds
    v_mfma_f32_32x32x16_bf16 v[96:111], a[92:95], v[152:155], v[96:111]
    s_add_u32 m0, s50, 18432
    s_add_u32 s54, s48, 60416
    buffer_load_dwordx4 v238, s[32:35], s54 offen lds
    v_mfma_f32_32x32x16_bf16 v[112:127], a[92:95], v[156:159], v[112:127]
    s_add_u32 m0, s50, 19456
    s_add_u32 s54, s48, 89088
    buffer_load_dwordx4 v239, s[32:35], s54 offen lds
    ds_read_b128 v[144:147], v194 offset:24576
    ds_read_b128 v[148:151], v194 offset:28672
    s_waitcnt lgkmcnt(4)
    v_mfma_f32_32x32x16_bf16 v[64:79], a[96:99], v[128:131], v[64:79]
    s_add_u32 m0, s50, 20480
    s_add_u32 s54, s48, 117760
    buffer_load_dwordx4 v238, s[32:35], s54 offen lds
    v_mfma_f32_32x32x16_bf16 v[80:95], a[96:99], v[132:135], v[80:95]
    s_add_u32 m0, s50, 21504
    s_add_u32 s54, s48, 146432
    buffer_load_dwordx4 v239, s[32:35], s54 offen lds
    v_mfma_f32_32x32x16_bf16 v[96:111], a[100:103], v[128:131], v[96:111]
    s_add_u32 m0, s50, 22528
    s_add_u32 s54, s48, 175104
    buffer_load_dwordx4 v238, s[32:35], s54 offen lds
    v_mfma_f32_32x32x16_bf16 v[112:127], a[100:103], v[132:135], v[112:127]
    s_add_u32 m0, s50, 23552
    s_add_u32 s54, s48, 203776
    buffer_load_dwordx4 v239, s[32:35], s54 offen lds
    ds_read_b128 v[152:155], v195 offset:24576
    ds_read_b128 v[156:159], v195 offset:28672
    s_waitcnt lgkmcnt(4)
    v_mfma_f32_32x32x16_bf16 v[64:79], a[104:107], v[136:139], v[64:79]
    v_mfma_f32_32x32x16_bf16 v[80:95], a[104:107], v[140:143], v[80:95]
    v_mfma_f32_32x32x16_bf16 v[96:111], a[108:111], v[136:139], v[96:111]
    v_mfma_f32_32x32x16_bf16 v[112:127], a[108:111], v[140:143], v[112:127]
    s_waitcnt vmcnt(16)
    ds_read_b128 v[128:131], v192 offset:0
    ds_read_b128 v[132:135], v192 offset:4096
    s_waitcnt lgkmcnt(4)
    v_mfma_f32_32x32x16_bf16 v[64:79], a[112:115], v[144:147], v[64:79]
    v_mfma_f32_32x32x16_bf16 v[80:95], a[112:115], v[148:151], v[80:95]
    v_mfma_f32_32x32x16_bf16 v[96:111], a[116:119], v[144:147], v[96:111]
    v_mfma_f32_32x32x16_bf16 v[112:127], a[116:119], v[148:151], v[112:127]
    ds_read_b128 v[136:139], v193 offset:0
    ds_read_b128 v[140:143], v193 offset:4096
    s_waitcnt lgkmcnt(4)
    v_mfma_f32_32x32x16_bf16 v[64:79], a[120:123], v[152:155], v[64:79]
    v_mfma_f32_32x32x16_bf16 v[80:95], a[120:123], v[156:159], v[80:95]
    v_mfma_f32_32x32x16_bf16 v[96:111], a[124:127], v[152:155], v[96:111]
    v_mfma_f32_32x32x16_bf16 v[112:127], a[124:127], v[156:159], v[112:127]
    ds_read_b128 v[144:147], v194 offset:0
    ds_read_b128 v[148:151], v194 offset:4096
    s_waitcnt lgkmcnt(4)
    v_mfma_f32_32x32x16_bf16 v[64:79], a[128:131], v[128:131], v[64:79]
    v_mfma_f32_32x32x16_bf16 v[80:95], a[128:131], v[132:135], v[80:95]
    v_mfma_f32_32x32x16_bf16 v[96:111], a[132:135], v[128:131], v[96:111]
    v_mfma_f32_32x32x16_bf16 v[112:127], a[132:135], v[132:135], v[112:127]
    ds_read_b128 v[152:155], v195 offset:0
    ds_read_b128 v[156:159], v195 offset:4096
    s_waitcnt lgkmcnt(4)
    v_mfma_f32_32x32x16_bf16 v[64:79], a[136:139], v[136:139], v[64:79]
    v_mfma_f32_32x32x16_bf16 v[80:95], a[136:139], v[140:143], v[80:95]
    v_mfma_f32_32x32x16_bf16 v[96:111], a[140:143], v[136:139], v[96:111]
    v_mfma_f32_32x32x16_bf16 v[112:127], a[140:143], v[140:143], v[112:127]
    s_waitcnt vmcnt(8)
    ds_read_b128 v[128:131], v192 offset:8192
    ds_read_b128 v[132:135], v192 offset:12288
    s_waitcnt lgkmcnt(4)
    v_mfma_f32_32x32x16_bf16 v[64:79], a[144:147], v[144:147], v[64:79]
    v_mfma_f32_32x32x16_bf16 v[80:95], a[144:147], v[148:151], v[80:95]
    v_mfma_f32_32x32x16_bf16 v[96:111], a[148:151], v[144:147], v[96:111]
    v_mfma_f32_32x32x16_bf16 v[112:127], a[148:151], v[148:151], v[112:127]
    ds_read_b128 v[136:139], v193 offset:8192
    ds_read_b128 v[140:143], v193 offset:12288
    s_waitcnt lgkmcnt(4)
    v_mfma_f32_32x32x16_bf16 v[64:79], a[152:155], v[152:155], v[64:79]
    v_mfma_f32_32x32x16_bf16 v[80:95], a[152:155], v[156:159], v[80:95]
    v_mfma_f32_32x32x16_bf16 v[96:111], a[156:159], v[152:155], v[96:111]
    v_mfma_f32_32x32x16_bf16 v[112:127], a[156:159], v[156:159], v[112:127]
    ds_read_b128 v[144:147], v194 offset:8192
    ds_read_b128 v[148:151], v194 offset:12288
    s_waitcnt lgkmcnt(4)
    v_mfma_f32_32x32x16_bf16 v[64:79], a[160:163], v[128:131], v[64:79]
    v_mfma_f32_32x32x16_bf16 v[80:95], a[160:163], v[132:135], v[80:95]
    v_mfma_f32_32x32x16_bf16 v[96:111], a[164:167], v[128:131], v[96:111]
    v_mfma_f32_32x32x16_bf16 v[112:127], a[164:167], v[132:135], v[112:127]
    ds_read_b128 v[152:155], v195 offset:8192
    ds_read_b128 v[156:159], v195 offset:12288
    s_waitcnt lgkmcnt(4)
    v_mfma_f32_32x32x16_bf16 v[64:79], a[168:171], v[136:139], v[64:79]
    v_mfma_f32_32x32x16_bf16 v[80:95], a[168:171], v[140:143], v[80:95]
    v_mfma_f32_32x32x16_bf16 v[96:111], a[172:175], v[136:139], v[96:111]
    v_mfma_f32_32x32x16_bf16 v[112:127], a[172:175], v[140:143], v[112:127]
    s_waitcnt vmcnt(0)
    ds_read_b128 v[128:131], v192 offset:16384
    ds_read_b128 v[132:135], v192 offset:20480
    s_waitcnt lgkmcnt(4)
    v_mfma_f32_32x32x16_bf16 v[64:79], a[176:179], v[144:147], v[64:79]
    v_mfma_f32_32x32x16_bf16 v[80:95], a[176:179], v[148:151], v[80:95]
    v_mfma_f32_32x32x16_bf16 v[96:111], a[180:183], v[144:147], v[96:111]
    v_mfma_f32_32x32x16_bf16 v[112:127], a[180:183], v[148:151], v[112:127]
    s_lshl_b32 s45, s61, 3
    s_add_u32 s45, s45, s58
    s_lshl_b32 s45, s45, 7
    s_add_u32 s45, s45, 13647872
    v_and_b32 v244, 31, v1
    v_lshlrev_b32 v244, 2, v244
    buffer_load_dword v245, v244, s[32:35], s45 offen sc1

    v_lshrrev_b32 v2, 3, v0
    v_and_b32 v3, 7, v0
    v_lshlrev_b32 v4, 12, v2
    v_lshl_add_u32 v4, v3, 4, v4
    s_lshl_b32 s43, s56, 11
    s_lshl_b32 s44, s55, 1
    s_add_u32 s43, s43, s44
    s_add_u32 s43, s43, 10485760
    s_add_u32 s44, s43, 131072
    v_mul_u32_u24 v5, 144, v2
    v_lshl_add_u32 v5, v3, 4, v5
    v_add_u32 v5, 69632, v5

    ds_read_b128 v[136:139], v193 offset:16384
    ds_read_b128 v[140:143], v193 offset:20480
    s_waitcnt lgkmcnt(4)
    v_mfma_f32_32x32x16_bf16 v[64:79], a[184:187], v[152:155], v[64:79]
    v_mfma_f32_32x32x16_bf16 v[80:95], a[184:187], v[156:159], v[80:95]
    v_mfma_f32_32x32x16_bf16 v[96:111], a[188:191], v[152:155], v[96:111]
    v_mfma_f32_32x32x16_bf16 v[112:127], a[188:191], v[156:159], v[112:127]
    ds_read_b128 v[144:147], v194 offset:16384
    ds_read_b128 v[148:151], v194 offset:20480
    s_waitcnt lgkmcnt(4)
    v_mfma_f32_32x32x16_bf16 v[64:79], a[192:195], v[128:131], v[64:79]
    v_mfma_f32_32x32x16_bf16 v[80:95], a[192:195], v[132:135], v[80:95]
    v_mfma_f32_32x32x16_bf16 v[96:111], a[196:199], v[128:131], v[96:111]
    v_mfma_f32_32x32x16_bf16 v[112:127], a[196:199], v[132:135], v[112:127]
    ds_read_b128 v[152:155], v195 offset:16384
    ds_read_b128 v[156:159], v195 offset:20480
    s_waitcnt lgkmcnt(4)
    v_mfma_f32_32x32x16_bf16 v[64:79], a[200:203], v[136:139], v[64:79]
    v_mfma_f32_32x32x16_bf16 v[80:95], a[200:203], v[140:143], v[80:95]
    v_mfma_f32_32x32x16_bf16 v[96:111], a[204:207], v[136:139], v[96:111]
    v_mfma_f32_32x32x16_bf16 v[112:127], a[204:207], v[140:143], v[112:127]
    s_waitcnt lgkmcnt(2)
    v_mfma_f32_32x32x16_bf16 v[64:79], a[208:211], v[144:147], v[64:79]
    v_mfma_f32_32x32x16_bf16 v[80:95], a[208:211], v[148:151], v[80:95]
    v_mfma_f32_32x32x16_bf16 v[96:111], a[212:215], v[144:147], v[96:111]
    v_mfma_f32_32x32x16_bf16 v[112:127], a[212:215], v[148:151], v[112:127]
    s_waitcnt vmcnt(0)
    v_cmp_ne_u32 vcc, 0, v245
    s_mov_b32 s46, 0
    s_cmp_eq_u64 vcc, -1
    s_cbranch_scc0 YNR_37
    s_mov_b32 s46, 1

    buffer_load_dwordx4 v[28:31], v4, s[32:35], s43 offen sc1
    buffer_load_dwordx4 v[32:35], v4, s[32:35], s44 offen sc1

YNR_37:
    s_waitcnt lgkmcnt(0)
    v_mfma_f32_32x32x16_bf16 v[64:79], a[216:219], v[152:155], v[64:79]
    v_mfma_f32_32x32x16_bf16 v[80:95], a[216:219], v[156:159], v[80:95]
    v_mfma_f32_32x32x16_bf16 v[96:111], a[220:223], v[152:155], v[96:111]
    v_mfma_f32_32x32x16_bf16 v[112:127], a[220:223], v[156:159], v[112:127]
    s_barrier
    s_cmp_eq_u32 s46, 1
    s_cbranch_scc1 YOK_38
    s_mov_b32 s62, 0
YP_39:
    buffer_load_dword v245, v244, s[32:35], s45 offen sc1
YPCK_41:
    s_waitcnt vmcnt(0)
    v_cmp_ne_u32 vcc, 0, v245
    s_add_u32 s62, s62, 1
    s_cmp_eq_u64 vcc, -1
    s_cbranch_scc1 YPOK_40
    s_cmp_ge_u32 s62, 32768
    s_cbranch_scc1 YPOK_40
    s_sleep 4
    s_branch YP_39

YPOK_40:
    buffer_load_dwordx4 v[28:31], v4, s[32:35], s43 offen sc1
    buffer_load_dwordx4 v[32:35], v4, s[32:35], s44 offen sc1

YOK_38:
    v_and_b32 v6, 31, v1
    v_mul_u32_u24 v6, 272, v6
    v_lshrrev_b32 v7, 5, v1
    v_lshl_add_u32 v6, v7, 4, v6
    s_mul_i32 s53, s3, 17408
    v_add_u32 v6, s53, v6
    s_nop 7

    ds_write_b128 v6, v[64:67] offset:0
    ds_write_b128 v6, v[68:71] offset:32
    ds_write_b128 v6, v[72:75] offset:64
    ds_write_b128 v6, v[76:79] offset:96
    ds_write_b128 v6, v[80:83] offset:8704
    ds_write_b128 v6, v[84:87] offset:8736
    ds_write_b128 v6, v[88:91] offset:8768
    ds_write_b128 v6, v[92:95] offset:8800
    ds_write_b128 v6, v[96:99] offset:128
    ds_write_b128 v6, v[100:103] offset:160
    ds_write_b128 v6, v[104:107] offset:192
    ds_write_b128 v6, v[108:111] offset:224
    ds_write_b128 v6, v[112:115] offset:8832
    ds_write_b128 v6, v[116:119] offset:8864
    ds_write_b128 v6, v[120:123] offset:8896
    ds_write_b128 v6, v[124:127] offset:8928
    s_waitcnt vmcnt(0)
    ds_write_b128 v5, v[28:31]
    ds_write_b128 v5, v[32:35] offset:4608
    s_waitcnt lgkmcnt(0)
    s_barrier
    v_mul_u32_u24 v6, 272, v11
    v_lshl_add_u32 v6, v13, 5, v6
    v_bfe_u32 v7, v1, 2, 2
    v_lshl_add_u32 v7, v13, 3, v7
    v_mul_u32_u24 v7, 144, v7
    v_and_b32 v8, 3, v1
    v_lshl_add_u32 v7, v8, 3, v7
    s_lshl_b32 s53, s3, 5
    s_add_u32 s53, s53, 69632
    v_add_u32 v7, s53, v7

    ds_read_b128 v[64:67], v6 offset:0
    ds_read_b128 v[68:71], v6 offset:16
    ds_read_b128 v[72:75], v6 offset:17408
    ds_read_b128 v[76:79], v6 offset:17424
    ds_read_b128 v[80:83], v6 offset:34816
    ds_read_b128 v[84:87], v6 offset:34832
    ds_read_b128 v[88:91], v6 offset:52224
    ds_read_b128 v[92:95], v6 offset:52240
    ds_read_b64_tr_b16 v[96:97], v7 offset:0
    ds_read_b64_tr_b16 v[98:99], v7 offset:576
    ds_read_b128 v[104:107], v6 offset:128
    ds_read_b128 v[108:111], v6 offset:144
    ds_read_b128 v[112:115], v6 offset:17536
    ds_read_b128 v[116:119], v6 offset:17552
    ds_read_b128 v[120:123], v6 offset:34944
    ds_read_b128 v[124:127], v6 offset:34960
    ds_read_b128 v[128:131], v6 offset:52352
    ds_read_b128 v[132:135], v6 offset:52368
    ds_read_b64_tr_b16 v[136:137], v7 offset:4608
    ds_read_b64_tr_b16 v[138:139], v7 offset:5184
    v_sub_f32 v25, 1.0, v24
    v_cvt_pk_bf16_f32 v25, v25, v25
    v_lshlrev_b32 v25, 16, v25
    s_waitcnt lgkmcnt(10)
    v_pk_add_f32 v[64:65], v[64:65], v[72:73]
    v_pk_add_f32 v[80:81], v[80:81], v[88:89]
    v_pk_add_f32 v[66:67], v[66:67], v[74:75]
    v_pk_add_f32 v[82:83], v[82:83], v[90:91]
    v_pk_add_f32 v[68:69], v[68:69], v[76:77]
    v_pk_add_f32 v[84:85], v[84:85], v[92:93]
    v_pk_add_f32 v[70:71], v[70:71], v[78:79]
    v_pk_add_f32 v[86:87], v[86:87], v[94:95]
    v_pk_add_f32 v[64:65], v[64:65], v[80:81]
    v_pk_add_f32 v[66:67], v[66:67], v[82:83]
    v_pk_add_f32 v[68:69], v[68:69], v[84:85]
    v_pk_add_f32 v[70:71], v[70:71], v[86:87]
    v_cvt_pk_bf16_f32 v36, v64, v65
    v_lshlrev_b32 v40, 16, v16
    v_and_b32 v41, 0xffff0000, v16
    v_lshlrev_b32 v42, 16, v96
    v_and_b32 v43, 0xffff0000, v96
    v_lshlrev_b32 v38, 16, v36
    v_and_b32 v39, 0xffff0000, v36
    v_pk_mul_f32 v[40:41], v[40:41], v[42:43]
    v_pk_mul_f32 v[38:39], v[38:39], v[24:25] op_sel:[0,1] op_sel_hi:[1,1]
    v_cvt_pk_bf16_f32 v37, v40, v41
    v_cvt_pk_bf16_f32 v36, v38, v39
    v_lshlrev_b32 v40, 16, v37
    v_and_b32 v41, 0xffff0000, v37
    v_lshlrev_b32 v38, 16, v36
    v_and_b32 v39, 0xffff0000, v36
    v_pk_mul_f32 v[40:41], v[40:41], v[24:25] op_sel:[0,0] op_sel_hi:[1,0]
    v_cvt_pk_bf16_f32 v37, v40, v41
    v_lshlrev_b32 v40, 16, v37
    v_and_b32 v41, 0xffff0000, v37
    v_pk_add_f32 v[38:39], v[38:39], v[40:41]
    v_cvt_pk_bf16_f32 v150, v38, v39
    v_cvt_pk_bf16_f32 v36, v66, v67
    v_lshlrev_b32 v40, 16, v17
    v_and_b32 v41, 0xffff0000, v17
    v_lshlrev_b32 v42, 16, v97
    v_and_b32 v43, 0xffff0000, v97
    v_lshlrev_b32 v38, 16, v36
    v_and_b32 v39, 0xffff0000, v36
    v_pk_mul_f32 v[40:41], v[40:41], v[42:43]
    v_pk_mul_f32 v[38:39], v[38:39], v[24:25] op_sel:[0,1] op_sel_hi:[1,1]
    v_cvt_pk_bf16_f32 v37, v40, v41
    v_cvt_pk_bf16_f32 v36, v38, v39
    v_lshlrev_b32 v40, 16, v37
    v_and_b32 v41, 0xffff0000, v37
    v_lshlrev_b32 v38, 16, v36
    v_and_b32 v39, 0xffff0000, v36
    v_pk_mul_f32 v[40:41], v[40:41], v[24:25] op_sel:[0,0] op_sel_hi:[1,0]
    v_cvt_pk_bf16_f32 v37, v40, v41
    v_lshlrev_b32 v40, 16, v37
    v_and_b32 v41, 0xffff0000, v37
    v_pk_add_f32 v[38:39], v[38:39], v[40:41]
    v_cvt_pk_bf16_f32 v151, v38, v39
    v_cvt_pk_bf16_f32 v36, v68, v69
    v_lshlrev_b32 v40, 16, v18
    v_and_b32 v41, 0xffff0000, v18
    v_lshlrev_b32 v42, 16, v98
    v_and_b32 v43, 0xffff0000, v98
    v_lshlrev_b32 v38, 16, v36
    v_and_b32 v39, 0xffff0000, v36
    v_pk_mul_f32 v[40:41], v[40:41], v[42:43]
    v_pk_mul_f32 v[38:39], v[38:39], v[24:25] op_sel:[0,1] op_sel_hi:[1,1]
    v_cvt_pk_bf16_f32 v37, v40, v41
    v_cvt_pk_bf16_f32 v36, v38, v39
    v_lshlrev_b32 v40, 16, v37
    v_and_b32 v41, 0xffff0000, v37
    v_lshlrev_b32 v38, 16, v36
    v_and_b32 v39, 0xffff0000, v36
    v_pk_mul_f32 v[40:41], v[40:41], v[24:25] op_sel:[0,0] op_sel_hi:[1,0]
    v_cvt_pk_bf16_f32 v37, v40, v41
    v_lshlrev_b32 v40, 16, v37
    v_and_b32 v41, 0xffff0000, v37
    v_pk_add_f32 v[38:39], v[38:39], v[40:41]
    v_cvt_pk_bf16_f32 v152, v38, v39
    v_cvt_pk_bf16_f32 v36, v70, v71
    v_lshlrev_b32 v40, 16, v19
    v_and_b32 v41, 0xffff0000, v19
    v_lshlrev_b32 v42, 16, v99
    v_and_b32 v43, 0xffff0000, v99
    v_lshlrev_b32 v38, 16, v36
    v_and_b32 v39, 0xffff0000, v36
    v_pk_mul_f32 v[40:41], v[40:41], v[42:43]
    v_pk_mul_f32 v[38:39], v[38:39], v[24:25] op_sel:[0,1] op_sel_hi:[1,1]
    v_cvt_pk_bf16_f32 v37, v40, v41
    v_cvt_pk_bf16_f32 v36, v38, v39
    v_lshlrev_b32 v40, 16, v37
    v_and_b32 v41, 0xffff0000, v37
    v_lshlrev_b32 v38, 16, v36
    v_and_b32 v39, 0xffff0000, v36
    v_pk_mul_f32 v[40:41], v[40:41], v[24:25] op_sel:[0,0] op_sel_hi:[1,0]
    v_cvt_pk_bf16_f32 v37, v40, v41
    v_lshlrev_b32 v40, 16, v37
    v_and_b32 v41, 0xffff0000, v37
    v_pk_add_f32 v[38:39], v[38:39], v[40:41]
    v_cvt_pk_bf16_f32 v153, v38, v39
    buffer_store_dwordx4 v[150:153], v14, s[12:15], s56 offen offset:0
    s_waitcnt lgkmcnt(0)
    v_pk_add_f32 v[104:105], v[104:105], v[112:113]
    v_pk_add_f32 v[120:121], v[120:121], v[128:129]
    v_pk_add_f32 v[106:107], v[106:107], v[114:115]
    v_pk_add_f32 v[122:123], v[122:123], v[130:131]
    v_pk_add_f32 v[108:109], v[108:109], v[116:117]
    v_pk_add_f32 v[124:125], v[124:125], v[132:133]
    v_pk_add_f32 v[110:111], v[110:111], v[118:119]
    v_pk_add_f32 v[126:127], v[126:127], v[134:135]
    v_pk_add_f32 v[104:105], v[104:105], v[120:121]
    v_pk_add_f32 v[106:107], v[106:107], v[122:123]
    v_pk_add_f32 v[108:109], v[108:109], v[124:125]
    v_pk_add_f32 v[110:111], v[110:111], v[126:127]
    v_cvt_pk_bf16_f32 v36, v104, v105
    v_lshlrev_b32 v40, 16, v20
    v_and_b32 v41, 0xffff0000, v20
    v_lshlrev_b32 v42, 16, v136
    v_and_b32 v43, 0xffff0000, v136
    v_lshlrev_b32 v38, 16, v36
    v_and_b32 v39, 0xffff0000, v36
    v_pk_mul_f32 v[40:41], v[40:41], v[42:43]
    v_pk_mul_f32 v[38:39], v[38:39], v[24:25] op_sel:[0,1] op_sel_hi:[1,1]
    v_cvt_pk_bf16_f32 v37, v40, v41
    v_cvt_pk_bf16_f32 v36, v38, v39
    v_lshlrev_b32 v40, 16, v37
    v_and_b32 v41, 0xffff0000, v37
    v_lshlrev_b32 v38, 16, v36
    v_and_b32 v39, 0xffff0000, v36
    v_pk_mul_f32 v[40:41], v[40:41], v[24:25] op_sel:[0,0] op_sel_hi:[1,0]
    v_cvt_pk_bf16_f32 v37, v40, v41
    v_lshlrev_b32 v40, 16, v37
    v_and_b32 v41, 0xffff0000, v37
    v_pk_add_f32 v[38:39], v[38:39], v[40:41]
    v_cvt_pk_bf16_f32 v154, v38, v39
    v_cvt_pk_bf16_f32 v36, v106, v107
    v_lshlrev_b32 v40, 16, v21
    v_and_b32 v41, 0xffff0000, v21
    v_lshlrev_b32 v42, 16, v137
    v_and_b32 v43, 0xffff0000, v137
    v_lshlrev_b32 v38, 16, v36
    v_and_b32 v39, 0xffff0000, v36
    v_pk_mul_f32 v[40:41], v[40:41], v[42:43]
    v_pk_mul_f32 v[38:39], v[38:39], v[24:25] op_sel:[0,1] op_sel_hi:[1,1]
    v_cvt_pk_bf16_f32 v37, v40, v41
    v_cvt_pk_bf16_f32 v36, v38, v39
    v_lshlrev_b32 v40, 16, v37
    v_and_b32 v41, 0xffff0000, v37
    v_lshlrev_b32 v38, 16, v36
    v_and_b32 v39, 0xffff0000, v36
    v_pk_mul_f32 v[40:41], v[40:41], v[24:25] op_sel:[0,0] op_sel_hi:[1,0]
    v_cvt_pk_bf16_f32 v37, v40, v41
    v_lshlrev_b32 v40, 16, v37
    v_and_b32 v41, 0xffff0000, v37
    v_pk_add_f32 v[38:39], v[38:39], v[40:41]
    v_cvt_pk_bf16_f32 v155, v38, v39
    v_cvt_pk_bf16_f32 v36, v108, v109
    v_lshlrev_b32 v40, 16, v22
    v_and_b32 v41, 0xffff0000, v22
    v_lshlrev_b32 v42, 16, v138
    v_and_b32 v43, 0xffff0000, v138
    v_lshlrev_b32 v38, 16, v36
    v_and_b32 v39, 0xffff0000, v36
    v_pk_mul_f32 v[40:41], v[40:41], v[42:43]
    v_pk_mul_f32 v[38:39], v[38:39], v[24:25] op_sel:[0,1] op_sel_hi:[1,1]
    v_cvt_pk_bf16_f32 v37, v40, v41
    v_cvt_pk_bf16_f32 v36, v38, v39
    v_lshlrev_b32 v40, 16, v37
    v_and_b32 v41, 0xffff0000, v37
    v_lshlrev_b32 v38, 16, v36
    v_and_b32 v39, 0xffff0000, v36
    v_pk_mul_f32 v[40:41], v[40:41], v[24:25] op_sel:[0,0] op_sel_hi:[1,0]
    v_cvt_pk_bf16_f32 v37, v40, v41
    v_lshlrev_b32 v40, 16, v37
    v_and_b32 v41, 0xffff0000, v37
    v_pk_add_f32 v[38:39], v[38:39], v[40:41]
    v_cvt_pk_bf16_f32 v156, v38, v39
    v_cvt_pk_bf16_f32 v36, v110, v111
    v_lshlrev_b32 v40, 16, v23
    v_and_b32 v41, 0xffff0000, v23
    v_lshlrev_b32 v42, 16, v139
    v_and_b32 v43, 0xffff0000, v139
    v_lshlrev_b32 v38, 16, v36
    v_and_b32 v39, 0xffff0000, v36
    v_pk_mul_f32 v[40:41], v[40:41], v[42:43]
    v_pk_mul_f32 v[38:39], v[38:39], v[24:25] op_sel:[0,1] op_sel_hi:[1,1]
    v_cvt_pk_bf16_f32 v37, v40, v41
    v_cvt_pk_bf16_f32 v36, v38, v39
    v_lshlrev_b32 v40, 16, v37
    v_and_b32 v41, 0xffff0000, v37
    v_lshlrev_b32 v38, 16, v36
    v_and_b32 v39, 0xffff0000, v36
    v_pk_mul_f32 v[40:41], v[40:41], v[24:25] op_sel:[0,0] op_sel_hi:[1,0]
    v_cvt_pk_bf16_f32 v37, v40, v41
    v_lshlrev_b32 v40, 16, v37
    v_and_b32 v41, 0xffff0000, v37
    v_pk_add_f32 v[38:39], v[38:39], v[40:41]
    v_cvt_pk_bf16_f32 v157, v38, v39
    buffer_store_dwordx4 v[154:157], v14, s[12:15], s56 offen offset:64
    s_waitcnt vmcnt(0)
P_END:
    s_endpgm
.section .rodata,"a"
.p2align 6
.amdhsa_kernel p_kernel
  .amdhsa_next_free_vgpr 512
  .amdhsa_next_free_sgpr 102
  .amdhsa_accum_offset 256
  .amdhsa_group_segment_fixed_size 0
  .amdhsa_kernarg_size 104
  .amdhsa_user_sgpr_count 2
  .amdhsa_user_sgpr_kernarg_segment_ptr 1
  .amdhsa_system_sgpr_workgroup_id_x 1
.end_amdhsa_kernel
```
